```python
import torch

def _softmax(x, axis=-1):
    return torch.softmax(x, dim=axis)
def _gelu(x):
    return torch.nn.functional.gelu(x, approximate="tanh")
def _silu(x):
    return torch.nn.functional.silu(x)
def _sigmoid(x):
    return torch.sigmoid(x)
def _layernorm(x, axis=-1, eps=1e-5):
    m = x.mean(dim=axis, keepdim=True)
    v = x.var(dim=axis, keepdim=True, unbiased=False)
    return (x - m) / torch.sqrt(v + eps)
def _scatter_add(tgt, idx, src, axis=0):
    return tgt.clone().index_add_(axis, idx, src)
def _segment_sum(src, seg, n):
    out = torch.zeros((n,) + src.shape[1:], dtype=src.dtype)
    return out.index_add_(0, seg, src)
def _pad(x, pw):
    flat = tuple(v for pair in reversed(pw) for v in pair)
    return torch.nn.functional.pad(x, flat)

kernel_name = 'parallel_sum__sliding_block_cached__mixer_token_mlp__decode'

def setup_inputs():

    _w = (lambda a: (lambda t: t.to(torch.bfloat16) if t.is_floating_point() else t)(torch.as_tensor(a)))
    def _A_setup():
        B, Sq, D = 4, 1, 512
        Hq, Hkv, Sk, Dh = 32, 32, 4096, 128
        assert Hq % Hkv == 0, (Hq, Hkv)
        return {
            "x": _w((lambda *s: torch.randn(*s, dtype=torch.bfloat16) * 0.05)(B, Sq, D)),
            "k_cache": _w((lambda *s: torch.randn(*s, dtype=torch.bfloat16) * 1.6)(B, Hkv, Sk, Dh)),
            "v_cache": _w((lambda *s: torch.randn(*s, dtype=torch.bfloat16) * 0.8)(B, Hkv, Sk, Dh)),
            "wq": _w((lambda *s: torch.randn(*s, dtype=torch.bfloat16) * 1.6)(D, Hq * Dh) * (D ** -0.5)),
            "wo": _w((lambda *s: torch.randn(*s, dtype=torch.bfloat16) * 0.8)(Hq * Dh, D) * ((Hq * Dh) ** -0.5)),
        }
    _A_in = _A_setup()

    def _B_setup():
        B, S, D, F = 4, 1, 512, 1376
        return {
            "x": _w((lambda *s: torch.randn(*s, dtype=torch.bfloat16) * 0.05)(B, S, D)),
            "w1": _w((lambda *s: torch.randn(*s, dtype=torch.bfloat16) * 3.2)(S, F) * (S ** -0.5)),
            "b1": _w((lambda *s: torch.randn(*s, dtype=torch.bfloat16) * 0.4)(F) * 0.02),
            "w2": _w((lambda *s: torch.randn(*s, dtype=torch.bfloat16) * 0.4)(F, S) * (F ** -0.5)),
            "b2": _w((lambda *s: torch.randn(*s, dtype=torch.bfloat16) * 0.4)(S) * 0.02),
        }
    _B_in = _B_setup()

    return {
        "A_x": _A_in["x"],
        "A_k_cache": _A_in["k_cache"],
        "A_v_cache": _A_in["v_cache"],
        "A_wq": _A_in["wq"],
        "A_wo": _A_in["wo"],
        "B_x": _B_in["x"],
        "B_w1": _B_in["w1"],
        "B_b1": _B_in["b1"],
        "B_w2": _B_in["w2"],
        "B_b2": _B_in["b2"],
    }

def reference(A_x, A_k_cache, A_v_cache, A_wq, A_wo, B_x, B_w1, B_b1, B_w2, B_b2):
    def _A_ref(x, k_cache, v_cache, wq, wo):
        B, Sq, D = x.shape
        Hq, Dh = 32, 128
        Hkv, Sk = k_cache.shape[1], k_cache.shape[2]
        W = min(4096, max(256, Sk // 4))
        rep = Hq // Hkv
        q = (lambda x, *d: x.permute(*d))((x @ wq).reshape(B, Sq, Hq, Dh), 0, 2, 1, 3)
        k = (lambda x, n, axis: torch.repeat_interleave(x, n, dim=axis))(k_cache[:, :, Sk - W:, :], rep, axis=1)
        v = (lambda x, n, axis: torch.repeat_interleave(x, n, dim=axis))(v_cache[:, :, Sk - W:, :], rep, axis=1)
        scores = torch.einsum("bhqd,bhkd->bhqk", q, k) * (Dh ** -0.5)
        p = _softmax(scores, axis=-1)
        o = torch.einsum("bhqk,bhkd->bhqd", p, v)
        return (lambda x, *d: x.permute(*d))(o, 0, 2, 1, 3).reshape(B, Sq, Hq * Dh) @ wo

    def _B_ref(x, w1, b1, w2, b2):
        B, S, D = x.shape
        h = _layernorm(x, axis=-1)
        u = torch.einsum("bsd,sf->bdf", h, w1) + b1
        u = _gelu(u)
        y = torch.einsum("bdf,fs->bds", u, w2) + b2
        return (lambda x, *d: x.permute(*d))(y, 0, 2, 1)

    x = A_x
    xn = _layernorm(x, axis=-1)
    return x + _A_ref(xn, A_k_cache, A_v_cache, A_wq, A_wo) + _B_ref(xn, B_w1, B_b1, B_w2, B_b2)
```

```asm
; @launch grid=(256,1,1) block=(512,1,1) lds=154448
.amdgcn_target "amdgcn-amd-amdhsa--gfx950"
.text
.globl parallel_sum__sliding_block_cached__mixer_token_mlp__decode_kernel
.p2align 12
.p2align 8
.type parallel_sum__sliding_block_cached__mixer_token_mlp__decode_kernel,@function
parallel_sum__sliding_block_cached__mixer_token_mlp__decode_kernel:
  s_load_dwordx16 s[4:19], s[0:1], 0
  s_load_dwordx8 s[20:27], s[0:1], 64
  s_load_dwordx2 s[28:29], s[0:1], 96
  s_cmpk_ge_u32 s2, 0x100
  s_cbranch_scc1 L_end
  v_lshrrev_b32 v2, 6, v0
  v_and_b32 v1, 63, v0
  v_readfirstlane_b32 s30, v2
  s_and_b32 s32, s2, 7
  s_lshr_b32 s33, s2, 3
  s_and_b32 s34, s33, 3
  s_lshl2_add_u32 s32, s32, s34
  s_lshr_b32 s33, s2, 5
  s_lshr_b32 s34, s33, 1
  s_and_b32 s38, s33, 1
  s_lshl_b32 s51, s34, 5
  s_add_u32 s51, s51, s32
  s_lshl_b32 s51, s51, 20
  s_add_u32 s35, s38, 6
  s_lshl_b32 s35, s35, 17
  s_and_b32 s31, s30, 3
  s_mul_i32 s36, s2, 5
  s_add_u32 s36, s36, s31
  s_lshl_b32 s36, s36, 12
  s_mov_b32 s39, 0x1f000
  s_mov_b32 s42, 0x100000
  s_mov_b32 s43, 0x20000
  s_mov_b32 s47, s43
  v_lshrrev_b32 v3, 4, v1
  v_and_b32 v6, 3, v1
  v_bfe_u32 v5, v1, 2, 2
  v_and_b32 v4, 15, v1
  s_cmp_lt_u32 s30, 4
  s_cbranch_scc1 L_G2
  v_lshlrev_b32 v10, 8, v5
  v_lshl_add_u32 v10, v3, 6, v10
  v_lshl_add_u32 v10, v6, 4, v10
  s_waitcnt lgkmcnt(0)
  s_add_u32 s40, s6, s51
  s_addc_u32 s41, s7, 0
  s_and_b32 s50, s36, s39
  s_or_b32 s50, s50, s35
  buffer_load_dwordx4 v[128:131], v10, s[40:43], s50 offen offset:0 nt
  buffer_load_dwordx4 v[132:135], v10, s[40:43], s50 offen offset:1024 nt
  s_barrier
  s_lshl1_add_u32 s37, s32, s38
  s_lshl_b32 s49, s31, 15
  v_lshlrev_b32 v7, 1, v3
  v_xor_b32 v7, v7, v4
  v_lshlrev_b32 v7, 4, v7
  v_lshl_add_u32 v11, v3, 10, v7
  v_xor_b32 v12, 128, v11
  s_lshl_b32 s51, s32, 17
  s_add_u32 s44, s12, s51
  s_addc_u32 s45, s13, 0
  s_mov_b32 s46, s43
  s_lshl_b32 s48, s31, 8
  s_mov_b32 m0, s49
  buffer_load_dwordx4 v[136:139], v10, s[40:43], s50 offen offset:2048 nt
  buffer_load_dwordx4 v11, s[44:47], s48 offen nt lds
  s_addk_i32 s48, 0x1000
  s_addk_i32 m0, 0x400
  buffer_load_dwordx4 v[140:143], v10, s[40:43], s50 offen offset:3072 nt
  buffer_load_dwordx4 v11, s[44:47], s48 offen nt lds
  s_addk_i32 s48, 0x1000
  s_addk_i32 m0, 0x400
  s_addk_i32 s36, 0x4000
  s_and_b32 s50, s36, s39
  s_or_b32 s50, s50, s35
  buffer_load_dwordx4 v[144:147], v10, s[40:43], s50 offen offset:0 nt
  buffer_load_dwordx4 v[148:151], v10, s[40:43], s50 offen offset:1024 nt
  buffer_load_dwordx4 v12, s[44:47], s48 offen nt lds
  s_addk_i32 s48, 0x1000
  s_addk_i32 m0, 0x400
  s_branch L_G1B
L_G2:
  s_setprio 3
  s_lshl1_add_u32 s37, s32, s38
  s_lshl_b32 s49, s31, 15
  v_lshlrev_b32 v10, 4, v1
  v_lshl_add_u32 v13, s31, 10, v10
  v_lshrrev_b32 v14, 3, v1
  v_and_b32 v7, 7, v1
  v_and_b32 v8, 1, v3
  v_lshlrev_b32 v8, 1, v8
  v_xor_b32 v7, v7, v8
  v_lshlrev_b32 v7, 4, v7
  v_lshl_add_u32 v14, v14, 13, v7
  v_xor_b32 v50, 64, v14
  s_lshr_b32 s48, s33, 1
  s_lshl2_add_u32 s48, s48, s31
  s_lshl_b32 s48, s48, 18
  s_and_b32 s53, s33, 1
  s_lshl1_add_u32 s53, s32, s53
  s_lshl_b32 s53, s53, 7
  s_add_u32 s53, s53, s48
  s_sub_u32 s46, 4194304, s53
  s_lshl_b32 s52, s31, 12
  s_add_u32 s52, s52, 131072
  s_mov_b32 m0, s52
  v_mov_b32 v9, 0
  v_mov_b32 v19, 154160
  v_lshl_add_u32 v16, s31, 2, v19
  ds_write_b32 v16, v9
  s_mov_b32 s48, 0
  s_waitcnt lgkmcnt(0)
  global_load_dwordx4 v[40:43], v13, s[4:5]
  s_add_u32 s44, s10, s53
  s_addc_u32 s45, s11, 0
  buffer_load_dwordx4 v14, s[44:47], s48 offen nt lds
  s_add_u32 s48, s48, 0x10000
  s_addk_i32 m0, 0x400
  s_nop 0
  buffer_load_dwordx4 v50, s[44:47], s48 offen nt lds
  s_add_u32 s48, s48, 0x10000
  s_addk_i32 m0, 0x400
  s_nop 0
  buffer_load_dwordx4 v14, s[44:47], s48 offen nt lds
  s_add_u32 s48, s48, 0x10000
  s_addk_i32 m0, 0x400
  s_nop 0
  buffer_load_dwordx4 v50, s[44:47], s48 offen nt lds
  s_load_dword s64, s[28:29], 0
  s_barrier
  s_add_u32 s40, s8, s51
  s_addc_u32 s41, s9, 0
  v_and_b32 v15, 1, v3
  v_lshlrev_b32 v15, 5, v15
  v_lshrrev_b32 v7, 1, v3
  v_lshl_add_u32 v15, v7, 4, v15
  v_add_u32 v15, v15, v6
  s_bfe_u32 s50, s37, 0x30002
  s_lshl_b32 s50, s50, 6
  s_and_b32 s51, s37, 3
  s_lshl2_add_u32 s50, s51, s50
  v_add_u32 v15, s50, v15
  s_lshl_b32 s50, s34, 9
  v_add_lshl_u32 v15, s50, v15, 1
  global_load_ushort v17, v15, s[4:5]
  global_load_ushort v18, v9, s[22:23]
  v_add_u32 v13, 147456, v13
  v_lshlrev_b32 v7, 10, v6
  v_lshl_add_u32 v7, v3, 4, v7
  s_lshr_b32 s50, s33, 1
  s_lshl_b32 s50, s50, 8
  s_add_u32 s50, s50, 147456
  v_add_u32 v7, s50, v7
  v_lshrrev_b32 v8, 1, v5
  v_and_b32 v20, 1, v3
  v_lshl_add_u32 v8, v20, 1, v8
  v_xor_b32 v8, s31, v8
  v_lshlrev_b32 v8, 5, v8
  v_lshl_add_u32 v8, v6, 3, v8
  v_lshl_add_u32 v20, v3, 3, v5
  v_lshl_add_u32 v8, v20, 7, v8
  v_add_u32 v8, 131072, v8
  s_waitcnt vmcnt(6)
  v_lshlrev_b32 v64, 16, v40
  v_and_b32 v65, 0xffff0000, v40
  v_lshlrev_b32 v66, 16, v41
  v_and_b32 v67, 0xffff0000, v41
  v_lshlrev_b32 v68, 16, v42
  v_and_b32 v69, 0xffff0000, v42
  v_lshlrev_b32 v70, 16, v43
  v_and_b32 v71, 0xffff0000, v43
  v_pk_add_f32 v[56:57], v[64:65], v[66:67]
  v_pk_add_f32 v[58:59], v[68:69], v[70:71]
  v_pk_add_f32 v[56:57], v[56:57], v[58:59]
  v_add_f32 v56, v56, v57
  s_nop 1
  v_add_f32_dpp v56, v56, v56 row_ror:8 row_mask:0xf bank_mask:0xf
  s_nop 1
  v_add_f32_dpp v56, v56, v56 row_ror:4 row_mask:0xf bank_mask:0xf
  s_nop 1
  v_add_f32_dpp v56, v56, v56 row_ror:2 row_mask:0xf bank_mask:0xf
  s_nop 1
  v_add_f32_dpp v56, v56, v56 row_ror:1 row_mask:0xf bank_mask:0xf
  v_mov_b32 v57, v56
  s_nop 1
  v_permlane16_swap_b32 v57, v56
  v_add_f32 v56, v56, v57
  v_mov_b32 v57, v56
  s_nop 1
  v_permlane32_swap_b32 v57, v56
  v_add_f32 v56, v56, v57
  v_mul_f32 v56, 0x3b000000, v56
  v_pk_add_f32 v[72:73], v[64:65], v[56:57] op_sel_hi:[1,0] neg_lo:[0,1] neg_hi:[0,1]
  v_pk_add_f32 v[74:75], v[66:67], v[56:57] op_sel_hi:[1,0] neg_lo:[0,1] neg_hi:[0,1]
  v_pk_add_f32 v[76:77], v[68:69], v[56:57] op_sel_hi:[1,0] neg_lo:[0,1] neg_hi:[0,1]
  v_pk_add_f32 v[78:79], v[70:71], v[56:57] op_sel_hi:[1,0] neg_lo:[0,1] neg_hi:[0,1]
  v_pk_mul_f32 v[58:59], v[72:73], v[72:73]
  v_pk_fma_f32 v[58:59], v[74:75], v[74:75], v[58:59]
  v_pk_fma_f32 v[58:59], v[76:77], v[76:77], v[58:59]
  v_pk_fma_f32 v[58:59], v[78:79], v[78:79], v[58:59]
  v_add_f32 v58, v58, v59
  v_cvt_pk_bf16_f32 v60, v56, v56
  v_and_b32 v60, 0xffff0000, v60
  v_add_f32_dpp v58, v58, v58 row_ror:8 row_mask:0xf bank_mask:0xf
  s_nop 1
  v_add_f32_dpp v58, v58, v58 row_ror:4 row_mask:0xf bank_mask:0xf
  s_nop 1
  v_add_f32_dpp v58, v58, v58 row_ror:2 row_mask:0xf bank_mask:0xf
  s_nop 1
  v_add_f32_dpp v58, v58, v58 row_ror:1 row_mask:0xf bank_mask:0xf
  v_pk_add_f32 v[64:65], v[64:65], v[60:61] op_sel_hi:[1,0] neg_lo:[0,1] neg_hi:[0,1]
  v_pk_add_f32 v[66:67], v[66:67], v[60:61] op_sel_hi:[1,0] neg_lo:[0,1] neg_hi:[0,1]
  v_pk_add_f32 v[68:69], v[68:69], v[60:61] op_sel_hi:[1,0] neg_lo:[0,1] neg_hi:[0,1]
  v_pk_add_f32 v[70:71], v[70:71], v[60:61] op_sel_hi:[1,0] neg_lo:[0,1] neg_hi:[0,1]
  v_mov_b32 v59, v58
  s_nop 1
  v_permlane16_swap_b32 v59, v58
  v_add_f32 v58, v58, v59
  v_mov_b32 v59, v58
  s_nop 1
  v_permlane32_swap_b32 v59, v58
  v_add_f32 v58, v58, v59
  v_cvt_pk_bf16_f32 v40, v64, v65
  v_cvt_pk_bf16_f32 v41, v66, v67
  v_cvt_pk_bf16_f32 v42, v68, v69
  v_cvt_pk_bf16_f32 v43, v70, v71
  v_mul_f32 v62, 0x3b000000, v58
  v_cvt_pk_bf16_f32 v62, v62, v62
  v_and_b32 v62, 0xffff0000, v62
  v_add_f32 v62, 0x3727c5ac, v62
  v_cvt_pk_bf16_f32 v62, v62, v62
  v_and_b32 v62, 0xffff0000, v62
  v_sqrt_f32 v62, v62
  v_lshlrev_b32 v64, 16, v40
  v_and_b32 v65, 0xffff0000, v40
  v_lshlrev_b32 v66, 16, v41
  v_and_b32 v67, 0xffff0000, v41
  v_lshlrev_b32 v68, 16, v42
  v_and_b32 v69, 0xffff0000, v42
  v_lshlrev_b32 v70, 16, v43
  v_and_b32 v71, 0xffff0000, v43
  v_cvt_pk_bf16_f32 v62, v62, v62
  v_and_b32 v62, 0xffff0000, v62
  v_rcp_f32 v62, v62
  s_nop 0
  v_pk_mul_f32 v[64:65], v[64:65], v[62:63] op_sel_hi:[1,0]
  v_pk_mul_f32 v[66:67], v[66:67], v[62:63] op_sel_hi:[1,0]
  v_pk_mul_f32 v[68:69], v[68:69], v[62:63] op_sel_hi:[1,0]
  v_pk_mul_f32 v[70:71], v[70:71], v[62:63] op_sel_hi:[1,0]
  v_cvt_pk_bf16_f32 v40, v64, v65
  v_cvt_pk_bf16_f32 v41, v66, v67
  v_cvt_pk_bf16_f32 v42, v68, v69
  v_cvt_pk_bf16_f32 v43, v70, v71
  ds_write_b128 v13, v[40:43]
  v_mov_b32 v9, 1
  s_waitcnt vmcnt(2) lgkmcnt(0)
  ds_write_b32 v16, v9
  s_mul_i32 s64, s64, 1664525
  s_add_u32 s64, s64, 1013904223
  s_and_b32 s65, s64, 0x3ff
  s_bfe_u32 s66, s64, 0xa000a
  s_bfe_u32 s67, s64, 0xa0014
  s_xor_b32 s68, s65, 0x154
  s_and_b32 s68, s68, 0x3fc
  s_lshr_b32 s69, s64, 30
  s_or_b32 s68, s68, s69
  s_getreg_b32 s58, hwreg(HW_REG_XCC_ID, 0, 4)
  s_bfe_u32 s59, s58, 0x10000
  s_lshl_b32 s59, s59, 9
  s_and_b32 s70, s65, 0x1ff
  s_or_b32 s70, s70, s59
  s_bfe_u32 s59, s58, 0x10001
  s_lshl_b32 s59, s59, 9
  s_and_b32 s71, s66, 0x1ff
  s_or_b32 s71, s71, s59
  s_bfe_u32 s59, s58, 0x10002
  s_lshl_b32 s59, s59, 9
  s_and_b32 s72, s67, 0x1ff
  s_or_b32 s72, s72, s59
  s_bfe_u32 s59, s58, 0x10003
  s_lshl_b32 s59, s59, 9
  s_and_b32 s73, s68, 0x1ff
  s_or_b32 s73, s73, s59
  s_mov_b32 s53, 200000
L_xnwait:
  ds_read_b128 v[20:23], v19
  s_sub_u32 s53, s53, 1
  s_cmp_eq_u32 s53, 0
  s_cbranch_scc1 L_xnok
  s_waitcnt lgkmcnt(0)
  v_and_b32 v20, v20, v21
  v_and_b32 v22, v22, v23
  v_and_b32 v20, v20, v22
  v_cmp_eq_u32 vcc, 0, v20
  s_cbranch_vccnz L_xnwait
L_xnok:
  ds_read_b128 v[64:67], v7 offset:0
  ds_read_b64_tr_b16 v[96:97], v8 offset:0
  ds_read_b64_tr_b16 v[98:99], v8 offset:512
  ds_read_b128 v[68:71], v7 offset:64
  ds_read_b64_tr_b16 v[100:101], v8 offset:4096
  ds_read_b64_tr_b16 v[102:103], v8 offset:4608
  ds_read_b128 v[72:75], v7 offset:128
  ds_read_b64_tr_b16 v[104:105], v8 offset:8192
  ds_read_b64_tr_b16 v[106:107], v8 offset:8704
  ds_read_b128 v[76:79], v7 offset:192
  ds_read_b64_tr_b16 v[108:109], v8 offset:12288
  ds_read_b64_tr_b16 v[110:111], v8 offset:12800
  v_mov_b32 v19, 0xfffffc00
  s_lshl_b32 s50, s32, 13
  s_add_u32 s50, s50, 65536
  v_lshlrev_b32 v49, 11, v6
  v_lshl_add_u32 v49, v3, 4, v49
  s_lshl2_add_u32 s51, s33, s31
  s_lshl_b32 s51, s51, 6
  s_add_u32 s51, s51, s50
  v_add_u32 v49, s51, v49
  v_bfe_u32 v20, v1, 2, 3
  v_lshlrev_b32 v21, 4, v6
  v_lshl_add_u32 v16, v20, 8, v21
  s_lshl_b32 s51, s34, 5
  s_add_u32 s51, s51, s31
  s_lshl_b32 s51, s51, 6
  s_add_u32 s51, s51, s50
  v_add_u32 v16, s51, v16
  s_mov_b32 s74, 0x000f000f
  s_mov_b32 s75, s74
  s_waitcnt lgkmcnt(9)
  v_mfma_f32_16x16x32_bf16 v[88:91], v[96:99], v[64:67], 0
  s_waitcnt lgkmcnt(6)
  v_mfma_f32_16x16x32_bf16 v[88:91], v[100:103], v[68:71], v[88:91]
  s_waitcnt lgkmcnt(3)
  v_mfma_f32_16x16x32_bf16 v[88:91], v[104:107], v[72:75], v[88:91]
  s_waitcnt lgkmcnt(0)
  v_mfma_f32_16x16x32_bf16 v[88:91], v[108:111], v[76:79], v[88:91]
  s_nop 7
  v_add_u32 v88, 0x200, v88
  v_add_u32 v89, 0x200, v89
  v_add_u32 v90, 0x200, v90
  v_add_u32 v91, 0x200, v91
  v_and_or_b32 v88, v88, v19, s70
  v_and_or_b32 v89, v89, v19, s71
  v_and_or_b32 v90, v90, v19, s72
  v_and_or_b32 v91, v91, v19, s73
  s_mov_b64 exec, s[74:75]
  global_store_dwordx4 v49, v[88:91], s[28:29]
  s_mov_b64 exec, -1
  s_cmp_lg_u32 s31, s34
  s_cbranch_scc1 L_noln2
  v_lshlrev_b32 v64, 16, v40
  v_and_b32 v65, 0xffff0000, v40
  v_lshlrev_b32 v66, 16, v41
  v_and_b32 v67, 0xffff0000, v41
  v_lshlrev_b32 v68, 16, v42
  v_and_b32 v69, 0xffff0000, v42
  v_lshlrev_b32 v70, 16, v43
  v_and_b32 v71, 0xffff0000, v43
  v_pk_add_f32 v[56:57], v[64:65], v[66:67]
  v_pk_add_f32 v[58:59], v[68:69], v[70:71]
  v_pk_add_f32 v[56:57], v[56:57], v[58:59]
  v_add_f32 v56, v56, v57
  s_nop 1
  v_add_f32_dpp v56, v56, v56 row_ror:8 row_mask:0xf bank_mask:0xf
  s_nop 1
  v_add_f32_dpp v56, v56, v56 row_ror:4 row_mask:0xf bank_mask:0xf
  s_nop 1
  v_add_f32_dpp v56, v56, v56 row_ror:2 row_mask:0xf bank_mask:0xf
  s_nop 1
  v_add_f32_dpp v56, v56, v56 row_ror:1 row_mask:0xf bank_mask:0xf
  v_mov_b32 v57, v56
  s_nop 1
  v_permlane16_swap_b32 v57, v56
  v_add_f32 v56, v56, v57
  v_mov_b32 v57, v56
  s_nop 1
  v_permlane32_swap_b32 v57, v56
  v_add_f32 v56, v56, v57
  v_mul_f32 v56, 0x3b000000, v56
  v_pk_add_f32 v[72:73], v[64:65], v[56:57] op_sel_hi:[1,0] neg_lo:[0,1] neg_hi:[0,1]
  v_pk_add_f32 v[74:75], v[66:67], v[56:57] op_sel_hi:[1,0] neg_lo:[0,1] neg_hi:[0,1]
  v_pk_add_f32 v[76:77], v[68:69], v[56:57] op_sel_hi:[1,0] neg_lo:[0,1] neg_hi:[0,1]
  v_pk_add_f32 v[78:79], v[70:71], v[56:57] op_sel_hi:[1,0] neg_lo:[0,1] neg_hi:[0,1]
  v_pk_mul_f32 v[58:59], v[72:73], v[72:73]
  v_pk_fma_f32 v[58:59], v[74:75], v[74:75], v[58:59]
  v_pk_fma_f32 v[58:59], v[76:77], v[76:77], v[58:59]
  v_pk_fma_f32 v[58:59], v[78:79], v[78:79], v[58:59]
  v_add_f32 v58, v58, v59
  v_cvt_pk_bf16_f32 v60, v56, v56
  v_and_b32 v60, 0xffff0000, v60
  v_add_f32_dpp v58, v58, v58 row_ror:8 row_mask:0xf bank_mask:0xf
  s_nop 1
  v_add_f32_dpp v58, v58, v58 row_ror:4 row_mask:0xf bank_mask:0xf
  s_nop 1
  v_add_f32_dpp v58, v58, v58 row_ror:2 row_mask:0xf bank_mask:0xf
  s_nop 1
  v_add_f32_dpp v58, v58, v58 row_ror:1 row_mask:0xf bank_mask:0xf
  v_pk_add_f32 v[64:65], v[64:65], v[60:61] op_sel_hi:[1,0] neg_lo:[0,1] neg_hi:[0,1]
  v_pk_add_f32 v[66:67], v[66:67], v[60:61] op_sel_hi:[1,0] neg_lo:[0,1] neg_hi:[0,1]
  v_pk_add_f32 v[68:69], v[68:69], v[60:61] op_sel_hi:[1,0] neg_lo:[0,1] neg_hi:[0,1]
  v_pk_add_f32 v[70:71], v[70:71], v[60:61] op_sel_hi:[1,0] neg_lo:[0,1] neg_hi:[0,1]
  v_mov_b32 v59, v58
  s_nop 1
  v_permlane16_swap_b32 v59, v58
  v_add_f32 v58, v58, v59
  v_mov_b32 v59, v58
  s_nop 1
  v_permlane32_swap_b32 v59, v58
  v_add_f32 v58, v58, v59
  v_cvt_pk_bf16_f32 v40, v64, v65
  v_cvt_pk_bf16_f32 v41, v66, v67
  v_cvt_pk_bf16_f32 v42, v68, v69
  v_cvt_pk_bf16_f32 v43, v70, v71
  v_mul_f32 v62, 0x3b000000, v58
  v_cvt_pk_bf16_f32 v62, v62, v62
  v_and_b32 v62, 0xffff0000, v62
  v_add_f32 v62, 0x3727c5ac, v62
  v_cvt_pk_bf16_f32 v62, v62, v62
  v_and_b32 v62, 0xffff0000, v62
  v_sqrt_f32 v62, v62
  v_lshlrev_b32 v64, 16, v40
  v_and_b32 v65, 0xffff0000, v40
  v_lshlrev_b32 v66, 16, v41
  v_and_b32 v67, 0xffff0000, v41
  v_lshlrev_b32 v68, 16, v42
  v_and_b32 v69, 0xffff0000, v42
  v_lshlrev_b32 v70, 16, v43
  v_and_b32 v71, 0xffff0000, v43
  v_cvt_pk_bf16_f32 v62, v62, v62
  v_and_b32 v62, 0xffff0000, v62
  v_rcp_f32 v62, v62
  s_nop 0
  v_pk_mul_f32 v[64:65], v[64:65], v[62:63] op_sel_hi:[1,0]
  v_pk_mul_f32 v[66:67], v[66:67], v[62:63] op_sel_hi:[1,0]
  v_pk_mul_f32 v[68:69], v[68:69], v[62:63] op_sel_hi:[1,0]
  v_pk_mul_f32 v[70:71], v[70:71], v[62:63] op_sel_hi:[1,0]
  v_cvt_pk_bf16_f32 v40, v64, v65
  v_cvt_pk_bf16_f32 v41, v66, v67
  v_cvt_pk_bf16_f32 v42, v68, v69
  v_cvt_pk_bf16_f32 v43, v70, v71
  v_add_u32 v7, 151552, v10
  ds_write_b128 v7, v[40:43]
L_noln2:
  v_lshlrev_b32 v7, 1, v3
  v_xor_b32 v7, v7, v4
  v_lshlrev_b32 v7, 4, v7
  v_lshl_add_u32 v11, v3, 10, v7
  v_xor_b32 v12, 128, v11
  s_lshl_b32 s51, s32, 17
  s_add_u32 s44, s12, s51
  s_addc_u32 s45, s13, 0
  s_mov_b32 s46, s43
  s_lshl_b32 s48, s31, 8
  s_add_u32 s48, s48, 69632
  s_add_u32 s50, s49, 17408
  s_mov_b32 m0, s50
  v_and_b32 v7, 1, v1
  v_lshlrev_b32 v7, 4, v7
  v_mov_b32 v8, 0xffff
  v_lshlrev_b32 v8, v7, v8
  v_lshrrev_b32 v7, 1, v4
  v_cmp_eq_u32 vcc, 0, v7
  s_nop 1
  v_cndmask_b32 v44, 0, v8, vcc
  v_cmp_eq_u32 vcc, 1, v7
  s_nop 1
  v_cndmask_b32 v45, 0, v8, vcc
  v_cmp_eq_u32 vcc, 2, v7
  s_nop 1
  v_cndmask_b32 v46, 0, v8, vcc
  v_cmp_eq_u32 vcc, 3, v7
  s_nop 1
  v_cndmask_b32 v47, 0, v8, vcc
  v_and_b32 v7, 1, v3
  v_lshl_add_u32 v7, v4, 1, v7
  v_lshlrev_b32 v7, 2, v7
  s_mul_i32 s50, s31, 144
  s_add_u32 s50, s50, 152832
  v_add_u32 v48, s50, v7
  v_add_u32 v8, 153984, v7
  v_mov_b32 v9, 0
  ds_write_b32 v8, v9
  v_mov_b32 v7, 154432
  v_mov_b32 v8, s64
  ds_write_b32 v7, v8
  s_mov_b32 s53, 200000
  s_mov_b32 s55, 3
  s_mov_b32 s54, 0
  s_movk_i32 s58, 0x200
  s_waitcnt vmcnt(0)
L_qpoll:
  global_load_dwordx4 v[20:23], v16, s[28:29] sc1
  s_sub_u32 s53, s53, 1
  s_cmp_eq_u32 s53, 0
  s_cbranch_scc1 L_qok
  s_sub_u32 s55, s55, 1
  s_cmp_eq_u32 s55, 0
  s_cselect_b32 s59, 1, 0
  s_waitcnt vmcnt(0)
  v_xor_b32 v24, s70, v20
  v_xor_b32 v25, s71, v21
  v_xor_b32 v26, s72, v22
  v_xor_b32 v27, s73, v23
  v_or3_b32 v28, v24, v25, v26
  v_or_b32 v28, v28, v27
  v_and_b32 v29, 0x3ff, v28
  v_and_b32 v28, 0x1ff, v28
  v_cmp_eq_u32 s[56:57], s58, v29
  v_cmp_ne_u32 vcc, 0, v28
  s_cmp_lg_u64 s[56:57], 0
  s_cselect_b32 s59, 1, s59
  s_andn2_b32 s59, s59, s54
  s_cbranch_scc0 L_qnext
  s_mov_b32 s54, 1
  s_mov_b64 exec, s[74:75]
  global_store_dwordx4 v49, v[88:91], s[28:29] sc1
  s_mov_b64 exec, -1
L_qnext:
  s_cbranch_vccnz L_qpoll
L_qok:
  v_add_f32_dpp v24, v24, v24 row_ror:8 row_mask:0xf bank_mask:0xf
  v_add_f32_dpp v25, v25, v25 row_ror:8 row_mask:0xf bank_mask:0xf
  v_add_f32_dpp v26, v26, v26 row_ror:8 row_mask:0xf bank_mask:0xf
  v_add_f32_dpp v27, v27, v27 row_ror:8 row_mask:0xf bank_mask:0xf
  v_permlane16_swap_b32 v24, v25
  s_nop 0
  v_permlane16_swap_b32 v26, v27
  v_add_f32 v24, v24, v25
  v_add_f32 v26, v26, v27
  s_nop 1
  v_permlane32_swap_b32 v24, v26
  v_cvt_pk_bf16_f32 v24, v24, v24
  v_and_b32 v7, 1, v5
  v_lshlrev_b32 v7, 7, v7
  v_lshl_add_u32 v7, v6, 3, v7
  v_lshl_add_u32 v7, v3, 1, v7
  s_lshl_b32 s50, s31, 5
  s_add_u32 s50, s50, 152576
  v_add_u32 v7, s50, v7
  ds_write_b16 v7, v24
  s_setprio 0
  s_waitcnt lgkmcnt(0)
  s_barrier
  s_and_b32 s50, s36, s39
  s_or_b32 s50, s50, s35
  buffer_load_dwordx4 v[128:131], v10, s[40:43], s50 offen offset:0 nt
  buffer_load_dwordx4 v11, s[44:47], s48 offen nt lds
  s_addk_i32 s48, 0x1000
  s_addk_i32 m0, 0x400
  buffer_load_dwordx4 v[132:135], v10, s[40:43], s50 offen offset:1024 nt
  buffer_load_dwordx4 v[136:139], v10, s[40:43], s50 offen offset:2048 nt
  buffer_load_dwordx4 v12, s[44:47], s48 offen nt lds
  s_addk_i32 s48, 0x1000
  s_addk_i32 m0, 0x400
  buffer_load_dwordx4 v[140:143], v10, s[40:43], s50 offen offset:3072 nt
  s_addk_i32 s36, 0x4000
  s_and_b32 s50, s36, s39
  s_or_b32 s50, s50, s35
  buffer_load_dwordx4 v[144:147], v10, s[40:43], s50 offen offset:0 nt
  buffer_load_dwordx4 v12, s[44:47], s48 offen nt lds
  s_addk_i32 s48, 0x1000
  s_addk_i32 m0, 0x400
  buffer_load_dwordx4 v[148:151], v10, s[40:43], s50 offen offset:1024 nt
  buffer_load_dwordx4 v[152:155], v10, s[40:43], s50 offen offset:2048 nt
  buffer_load_dwordx4 v11, s[44:47], s48 offen nt lds
  s_addk_i32 s48, 0x1000
  s_addk_i32 m0, 0x400
  buffer_load_dwordx4 v[156:159], v10, s[40:43], s50 offen offset:3072 nt
  s_addk_i32 s36, 0x4000
  s_and_b32 s50, s36, s39
  s_or_b32 s50, s50, s35
  buffer_load_dwordx4 v[160:163], v10, s[40:43], s50 offen offset:0 nt
  buffer_load_dwordx4 v11, s[44:47], s48 offen nt lds
  s_addk_i32 s48, 0x1000
  s_addk_i32 m0, 0x400
  buffer_load_dwordx4 v[164:167], v10, s[40:43], s50 offen offset:1024 nt
  buffer_load_dwordx4 v12, s[44:47], s48 offen nt lds
  s_addk_i32 s48, 0x1000
  s_addk_i32 m0, 0x400
  buffer_load_dwordx4 v[168:171], v10, s[40:43], s50 offen offset:2048 nt
  buffer_load_dwordx4 v[172:175], v10, s[40:43], s50 offen offset:3072 nt
  buffer_load_dwordx4 v12, s[44:47], s48 offen nt lds
  s_addk_i32 s48, 0x1000
  s_addk_i32 m0, 0x400
  s_addk_i32 s36, 0x4000
  s_and_b32 s50, s36, s39
  s_or_b32 s50, s50, s35
  buffer_load_dwordx4 v[176:179], v10, s[40:43], s50 offen offset:0 nt
  buffer_load_dwordx4 v[180:183], v10, s[40:43], s50 offen offset:1024 nt
  buffer_load_dwordx4 v11, s[44:47], s48 offen nt lds
  s_addk_i32 s48, 0x1000
  s_addk_i32 m0, 0x400
  buffer_load_dwordx4 v[184:187], v10, s[40:43], s50 offen offset:2048 nt
  buffer_load_dwordx4 v[188:191], v10, s[40:43], s50 offen offset:3072 nt
  buffer_load_dwordx4 v11, s[44:47], s48 offen nt lds
  s_addk_i32 s48, 0x1000
  s_addk_i32 m0, 0x400
  s_addk_i32 s36, 0x4000
  s_and_b32 s50, s36, s39
  s_or_b32 s50, s50, s35
  buffer_load_dwordx4 v[192:195], v10, s[40:43], s50 offen offset:0 nt
  buffer_load_dwordx4 v[196:199], v10, s[40:43], s50 offen offset:1024 nt
  buffer_load_dwordx4 v12, s[44:47], s48 offen nt lds
  s_addk_i32 s48, 0x1000
  s_addk_i32 m0, 0x400
  buffer_load_dwordx4 v[200:203], v10, s[40:43], s50 offen offset:2048 nt
  buffer_load_dwordx4 v12, s[44:47], s48 offen nt lds
  s_addk_i32 s48, 0x1000
  s_addk_i32 m0, 0x400
  buffer_load_dwordx4 v[204:207], v10, s[40:43], s50 offen offset:3072 nt
  s_addk_i32 s36, 0x4000
  s_and_b32 s50, s36, s39
  s_or_b32 s50, s50, s35
  buffer_load_dwordx4 v[208:211], v10, s[40:43], s50 offen offset:0 nt
  buffer_load_dwordx4 v11, s[44:47], s48 offen nt lds
  s_addk_i32 s48, 0x1000
  s_addk_i32 m0, 0x400
  buffer_load_dwordx4 v[212:215], v10, s[40:43], s50 offen offset:1024 nt
  buffer_load_dwordx4 v[216:219], v10, s[40:43], s50 offen offset:2048 nt
  buffer_load_dwordx4 v11, s[44:47], s48 offen nt lds
  s_addk_i32 s48, 0x1000
  s_addk_i32 m0, 0x400
  buffer_load_dwordx4 v[220:223], v10, s[40:43], s50 offen offset:3072 nt
  s_addk_i32 s36, 0x4000
  s_and_b32 s50, s36, s39
  s_or_b32 s50, s50, s35
  buffer_load_dwordx4 v[224:227], v10, s[40:43], s50 offen offset:0 nt
  buffer_load_dwordx4 v12, s[44:47], s48 offen nt lds
  s_addk_i32 s48, 0x1000
  s_addk_i32 m0, 0x400
  buffer_load_dwordx4 v[228:231], v10, s[40:43], s50 offen offset:1024 nt
  buffer_load_dwordx4 v[232:235], v10, s[40:43], s50 offen offset:2048 nt
  buffer_load_dwordx4 v12, s[44:47], s48 offen nt lds
  s_addk_i32 s48, 0x1000
  s_addk_i32 m0, 0x400
  buffer_load_dwordx4 v[236:239], v10, s[40:43], s50 offen offset:3072 nt
  s_addk_i32 s36, 0x4000
  s_and_b32 s50, s36, s39
  s_or_b32 s50, s50, s35
  buffer_load_dwordx4 v[240:243], v10, s[40:43], s50 offen offset:0 nt
  buffer_load_dwordx4 v[244:247], v10, s[40:43], s50 offen offset:1024 nt
  buffer_load_dwordx4 v[248:251], v10, s[40:43], s50 offen offset:2048 nt
  buffer_load_dwordx4 v[252:255], v10, s[40:43], s50 offen offset:3072 nt
L_vdone:
  v_lshlrev_b32 v17, 16, v17
  v_lshlrev_b32 v18, 16, v18
  s_lshl_b32 s50, s31, 11
  s_add_u32 s50, s50, 131072
  v_add_u32 v7, s50, v10
  v_mov_b32 v8, 154128
  v_lshl_add_u32 v9, s31, 3, v8
  s_barrier
  ds_read_b128 v[32:35], v7
  ds_read_b128 v[36:39], v7 offset:1024
  ds_read_b128 v[20:23], v8
  ds_read_b128 v[24:27], v8 offset:16
  ds_read_b32 v28, v9
  s_waitcnt lgkmcnt(0)
  v_and_b32_dpp v56, v32, v44 row_newbcast:0 row_mask:0xf bank_mask:0xf
  v_and_b32_dpp v57, v32, v45 row_newbcast:0 row_mask:0xf bank_mask:0xf
  v_and_b32_dpp v58, v32, v46 row_newbcast:0 row_mask:0xf bank_mask:0xf
  v_and_b32_dpp v59, v32, v47 row_newbcast:0 row_mask:0xf bank_mask:0xf
  v_max3_f32 v30, v20, v22, v24
  v_max_f32 v30, v30, v26
  v_sub_f32 v20, v20, v30
  v_sub_f32 v22, v22, v30
  v_sub_f32 v24, v24, v30
  v_sub_f32 v26, v26, v30
  v_sub_f32 v28, v28, v30
  v_exp_f32 v20, v20
  v_exp_f32 v22, v22
  v_exp_f32 v24, v24
  v_exp_f32 v26, v26
  v_exp_f32 v28, v28
  v_mul_f32 v29, v20, v21
  v_fmac_f32 v29, v22, v23
  v_fmac_f32 v29, v24, v25
  v_fmac_f32 v29, v26, v27
  v_rcp_f32 v29, v29
  s_nop 0
  v_mul_f32 v30, v28, v29
  v_and_b32_dpp v60, v32, v44 row_newbcast:4 row_mask:0xf bank_mask:0xf
  v_and_b32_dpp v61, v32, v45 row_newbcast:4 row_mask:0xf bank_mask:0xf
  v_and_b32_dpp v62, v32, v46 row_newbcast:4 row_mask:0xf bank_mask:0xf
  v_and_b32_dpp v63, v32, v47 row_newbcast:4 row_mask:0xf bank_mask:0xf
  s_waitcnt vmcnt(41)
  v_mfma_f32_16x16x32_bf16 v[64:67], v[56:59], v[128:131], 0
  v_and_b32_dpp v56, v32, v44 row_newbcast:8 row_mask:0xf bank_mask:0xf
  v_and_b32_dpp v57, v32, v45 row_newbcast:8 row_mask:0xf bank_mask:0xf
  v_and_b32_dpp v58, v32, v46 row_newbcast:8 row_mask:0xf bank_mask:0xf
  v_and_b32_dpp v59, v32, v47 row_newbcast:8 row_mask:0xf bank_mask:0xf
  v_mfma_f32_16x16x32_bf16 v[64:67], v[60:63], v[132:135], v[64:67]
  v_and_b32_dpp v60, v32, v44 row_newbcast:12 row_mask:0xf bank_mask:0xf
  v_and_b32_dpp v61, v32, v45 row_newbcast:12 row_mask:0xf bank_mask:0xf
  v_and_b32_dpp v62, v32, v46 row_newbcast:12 row_mask:0xf bank_mask:0xf
  v_and_b32_dpp v63, v32, v47 row_newbcast:12 row_mask:0xf bank_mask:0xf
  v_mfma_f32_16x16x32_bf16 v[64:67], v[56:59], v[136:139], v[64:67]
  v_and_b32_dpp v56, v33, v44 row_newbcast:0 row_mask:0xf bank_mask:0xf
  v_and_b32_dpp v57, v33, v45 row_newbcast:0 row_mask:0xf bank_mask:0xf
  v_and_b32_dpp v58, v33, v46 row_newbcast:0 row_mask:0xf bank_mask:0xf
  v_and_b32_dpp v59, v33, v47 row_newbcast:0 row_mask:0xf bank_mask:0xf
  v_mfma_f32_16x16x32_bf16 v[64:67], v[60:63], v[140:143], v[64:67]
  v_and_b32_dpp v60, v33, v44 row_newbcast:4 row_mask:0xf bank_mask:0xf
  v_and_b32_dpp v61, v33, v45 row_newbcast:4 row_mask:0xf bank_mask:0xf
  v_and_b32_dpp v62, v33, v46 row_newbcast:4 row_mask:0xf bank_mask:0xf
  v_and_b32_dpp v63, v33, v47 row_newbcast:4 row_mask:0xf bank_mask:0xf
  s_waitcnt vmcnt(35)
  v_mfma_f32_16x16x32_bf16 v[64:67], v[56:59], v[144:147], v[64:67]
  v_and_b32_dpp v56, v33, v44 row_newbcast:8 row_mask:0xf bank_mask:0xf
  v_and_b32_dpp v57, v33, v45 row_newbcast:8 row_mask:0xf bank_mask:0xf
  v_and_b32_dpp v58, v33, v46 row_newbcast:8 row_mask:0xf bank_mask:0xf
  v_and_b32_dpp v59, v33, v47 row_newbcast:8 row_mask:0xf bank_mask:0xf
  v_mfma_f32_16x16x32_bf16 v[64:67], v[60:63], v[148:151], v[64:67]
  v_and_b32_dpp v60, v33, v44 row_newbcast:12 row_mask:0xf bank_mask:0xf
  v_and_b32_dpp v61, v33, v45 row_newbcast:12 row_mask:0xf bank_mask:0xf
  v_and_b32_dpp v62, v33, v46 row_newbcast:12 row_mask:0xf bank_mask:0xf
  v_and_b32_dpp v63, v33, v47 row_newbcast:12 row_mask:0xf bank_mask:0xf
  v_mfma_f32_16x16x32_bf16 v[64:67], v[56:59], v[152:155], v[64:67]
  v_and_b32_dpp v56, v34, v44 row_newbcast:0 row_mask:0xf bank_mask:0xf
  v_and_b32_dpp v57, v34, v45 row_newbcast:0 row_mask:0xf bank_mask:0xf
  v_and_b32_dpp v58, v34, v46 row_newbcast:0 row_mask:0xf bank_mask:0xf
  v_and_b32_dpp v59, v34, v47 row_newbcast:0 row_mask:0xf bank_mask:0xf
  v_mfma_f32_16x16x32_bf16 v[64:67], v[60:63], v[156:159], v[64:67]
  v_and_b32_dpp v60, v34, v44 row_newbcast:4 row_mask:0xf bank_mask:0xf
  v_and_b32_dpp v61, v34, v45 row_newbcast:4 row_mask:0xf bank_mask:0xf
  v_and_b32_dpp v62, v34, v46 row_newbcast:4 row_mask:0xf bank_mask:0xf
  v_and_b32_dpp v63, v34, v47 row_newbcast:4 row_mask:0xf bank_mask:0xf
  s_waitcnt vmcnt(29)
  v_mfma_f32_16x16x32_bf16 v[64:67], v[56:59], v[160:163], v[64:67]
  v_and_b32_dpp v56, v34, v44 row_newbcast:8 row_mask:0xf bank_mask:0xf
  v_and_b32_dpp v57, v34, v45 row_newbcast:8 row_mask:0xf bank_mask:0xf
  v_and_b32_dpp v58, v34, v46 row_newbcast:8 row_mask:0xf bank_mask:0xf
  v_and_b32_dpp v59, v34, v47 row_newbcast:8 row_mask:0xf bank_mask:0xf
  v_mfma_f32_16x16x32_bf16 v[64:67], v[60:63], v[164:167], v[64:67]
  v_and_b32_dpp v60, v34, v44 row_newbcast:12 row_mask:0xf bank_mask:0xf
  v_and_b32_dpp v61, v34, v45 row_newbcast:12 row_mask:0xf bank_mask:0xf
  v_and_b32_dpp v62, v34, v46 row_newbcast:12 row_mask:0xf bank_mask:0xf
  v_and_b32_dpp v63, v34, v47 row_newbcast:12 row_mask:0xf bank_mask:0xf
  v_mfma_f32_16x16x32_bf16 v[64:67], v[56:59], v[168:171], v[64:67]
  v_and_b32_dpp v56, v35, v44 row_newbcast:0 row_mask:0xf bank_mask:0xf
  v_and_b32_dpp v57, v35, v45 row_newbcast:0 row_mask:0xf bank_mask:0xf
  v_and_b32_dpp v58, v35, v46 row_newbcast:0 row_mask:0xf bank_mask:0xf
  v_and_b32_dpp v59, v35, v47 row_newbcast:0 row_mask:0xf bank_mask:0xf
  v_mfma_f32_16x16x32_bf16 v[64:67], v[60:63], v[172:175], v[64:67]
  v_and_b32_dpp v60, v35, v44 row_newbcast:4 row_mask:0xf bank_mask:0xf
  v_and_b32_dpp v61, v35, v45 row_newbcast:4 row_mask:0xf bank_mask:0xf
  v_and_b32_dpp v62, v35, v46 row_newbcast:4 row_mask:0xf bank_mask:0xf
  v_and_b32_dpp v63, v35, v47 row_newbcast:4 row_mask:0xf bank_mask:0xf
  s_waitcnt vmcnt(27)
  v_mfma_f32_16x16x32_bf16 v[64:67], v[56:59], v[176:179], v[64:67]
  v_and_b32_dpp v56, v35, v44 row_newbcast:8 row_mask:0xf bank_mask:0xf
  v_and_b32_dpp v57, v35, v45 row_newbcast:8 row_mask:0xf bank_mask:0xf
  v_and_b32_dpp v58, v35, v46 row_newbcast:8 row_mask:0xf bank_mask:0xf
  v_and_b32_dpp v59, v35, v47 row_newbcast:8 row_mask:0xf bank_mask:0xf
  s_waitcnt vmcnt(26)
  v_mfma_f32_16x16x32_bf16 v[64:67], v[60:63], v[180:183], v[64:67]
  v_and_b32_dpp v60, v35, v44 row_newbcast:12 row_mask:0xf bank_mask:0xf
  v_and_b32_dpp v61, v35, v45 row_newbcast:12 row_mask:0xf bank_mask:0xf
  v_and_b32_dpp v62, v35, v46 row_newbcast:12 row_mask:0xf bank_mask:0xf
  v_and_b32_dpp v63, v35, v47 row_newbcast:12 row_mask:0xf bank_mask:0xf
  s_waitcnt vmcnt(24)
  v_mfma_f32_16x16x32_bf16 v[64:67], v[56:59], v[184:187], v[64:67]
  v_and_b32_dpp v56, v36, v44 row_newbcast:0 row_mask:0xf bank_mask:0xf
  v_and_b32_dpp v57, v36, v45 row_newbcast:0 row_mask:0xf bank_mask:0xf
  v_and_b32_dpp v58, v36, v46 row_newbcast:0 row_mask:0xf bank_mask:0xf
  v_and_b32_dpp v59, v36, v47 row_newbcast:0 row_mask:0xf bank_mask:0xf
  s_waitcnt vmcnt(23)
  v_mfma_f32_16x16x32_bf16 v[64:67], v[60:63], v[188:191], v[64:67]
  v_and_b32_dpp v60, v36, v44 row_newbcast:4 row_mask:0xf bank_mask:0xf
  v_and_b32_dpp v61, v36, v45 row_newbcast:4 row_mask:0xf bank_mask:0xf
  v_and_b32_dpp v62, v36, v46 row_newbcast:4 row_mask:0xf bank_mask:0xf
  v_and_b32_dpp v63, v36, v47 row_newbcast:4 row_mask:0xf bank_mask:0xf
  s_waitcnt vmcnt(21)
  v_mfma_f32_16x16x32_bf16 v[64:67], v[56:59], v[192:195], v[64:67]
  v_and_b32_dpp v56, v36, v44 row_newbcast:8 row_mask:0xf bank_mask:0xf
  v_and_b32_dpp v57, v36, v45 row_newbcast:8 row_mask:0xf bank_mask:0xf
  v_and_b32_dpp v58, v36, v46 row_newbcast:8 row_mask:0xf bank_mask:0xf
  v_and_b32_dpp v59, v36, v47 row_newbcast:8 row_mask:0xf bank_mask:0xf
  s_waitcnt vmcnt(20)
  v_mfma_f32_16x16x32_bf16 v[64:67], v[60:63], v[196:199], v[64:67]
  v_and_b32_dpp v60, v36, v44 row_newbcast:12 row_mask:0xf bank_mask:0xf
  v_and_b32_dpp v61, v36, v45 row_newbcast:12 row_mask:0xf bank_mask:0xf
  v_and_b32_dpp v62, v36, v46 row_newbcast:12 row_mask:0xf bank_mask:0xf
  v_and_b32_dpp v63, v36, v47 row_newbcast:12 row_mask:0xf bank_mask:0xf
  s_waitcnt vmcnt(18)
  v_mfma_f32_16x16x32_bf16 v[64:67], v[56:59], v[200:203], v[64:67]
  v_and_b32_dpp v56, v37, v44 row_newbcast:0 row_mask:0xf bank_mask:0xf
  v_and_b32_dpp v57, v37, v45 row_newbcast:0 row_mask:0xf bank_mask:0xf
  v_and_b32_dpp v58, v37, v46 row_newbcast:0 row_mask:0xf bank_mask:0xf
  v_and_b32_dpp v59, v37, v47 row_newbcast:0 row_mask:0xf bank_mask:0xf
  s_waitcnt vmcnt(16)
  v_mfma_f32_16x16x32_bf16 v[64:67], v[60:63], v[204:207], v[64:67]
  v_and_b32_dpp v60, v37, v44 row_newbcast:4 row_mask:0xf bank_mask:0xf
  v_and_b32_dpp v61, v37, v45 row_newbcast:4 row_mask:0xf bank_mask:0xf
  v_and_b32_dpp v62, v37, v46 row_newbcast:4 row_mask:0xf bank_mask:0xf
  v_and_b32_dpp v63, v37, v47 row_newbcast:4 row_mask:0xf bank_mask:0xf
  s_waitcnt vmcnt(15)
  v_mfma_f32_16x16x32_bf16 v[64:67], v[56:59], v[208:211], v[64:67]
  v_and_b32_dpp v56, v37, v44 row_newbcast:8 row_mask:0xf bank_mask:0xf
  v_and_b32_dpp v57, v37, v45 row_newbcast:8 row_mask:0xf bank_mask:0xf
  v_and_b32_dpp v58, v37, v46 row_newbcast:8 row_mask:0xf bank_mask:0xf
  v_and_b32_dpp v59, v37, v47 row_newbcast:8 row_mask:0xf bank_mask:0xf
  s_waitcnt vmcnt(13)
  v_mfma_f32_16x16x32_bf16 v[64:67], v[60:63], v[212:215], v[64:67]
  v_and_b32_dpp v60, v37, v44 row_newbcast:12 row_mask:0xf bank_mask:0xf
  v_and_b32_dpp v61, v37, v45 row_newbcast:12 row_mask:0xf bank_mask:0xf
  v_and_b32_dpp v62, v37, v46 row_newbcast:12 row_mask:0xf bank_mask:0xf
  v_and_b32_dpp v63, v37, v47 row_newbcast:12 row_mask:0xf bank_mask:0xf
  s_waitcnt vmcnt(12)
  v_mfma_f32_16x16x32_bf16 v[64:67], v[56:59], v[216:219], v[64:67]
  v_and_b32_dpp v56, v38, v44 row_newbcast:0 row_mask:0xf bank_mask:0xf
  v_and_b32_dpp v57, v38, v45 row_newbcast:0 row_mask:0xf bank_mask:0xf
  v_and_b32_dpp v58, v38, v46 row_newbcast:0 row_mask:0xf bank_mask:0xf
  v_and_b32_dpp v59, v38, v47 row_newbcast:0 row_mask:0xf bank_mask:0xf
  s_waitcnt vmcnt(10)
  v_mfma_f32_16x16x32_bf16 v[64:67], v[60:63], v[220:223], v[64:67]
  v_and_b32_dpp v60, v38, v44 row_newbcast:4 row_mask:0xf bank_mask:0xf
  v_and_b32_dpp v61, v38, v45 row_newbcast:4 row_mask:0xf bank_mask:0xf
  v_and_b32_dpp v62, v38, v46 row_newbcast:4 row_mask:0xf bank_mask:0xf
  v_and_b32_dpp v63, v38, v47 row_newbcast:4 row_mask:0xf bank_mask:0xf
  s_waitcnt vmcnt(9)
  v_mfma_f32_16x16x32_bf16 v[64:67], v[56:59], v[224:227], v[64:67]
  v_and_b32_dpp v56, v38, v44 row_newbcast:8 row_mask:0xf bank_mask:0xf
  v_and_b32_dpp v57, v38, v45 row_newbcast:8 row_mask:0xf bank_mask:0xf
  v_and_b32_dpp v58, v38, v46 row_newbcast:8 row_mask:0xf bank_mask:0xf
  v_and_b32_dpp v59, v38, v47 row_newbcast:8 row_mask:0xf bank_mask:0xf
  s_waitcnt vmcnt(7)
  v_mfma_f32_16x16x32_bf16 v[64:67], v[60:63], v[228:231], v[64:67]
  v_and_b32_dpp v60, v38, v44 row_newbcast:12 row_mask:0xf bank_mask:0xf
  v_and_b32_dpp v61, v38, v45 row_newbcast:12 row_mask:0xf bank_mask:0xf
  v_and_b32_dpp v62, v38, v46 row_newbcast:12 row_mask:0xf bank_mask:0xf
  v_and_b32_dpp v63, v38, v47 row_newbcast:12 row_mask:0xf bank_mask:0xf
  s_waitcnt vmcnt(6)
  v_mfma_f32_16x16x32_bf16 v[64:67], v[56:59], v[232:235], v[64:67]
  v_and_b32_dpp v56, v39, v44 row_newbcast:0 row_mask:0xf bank_mask:0xf
  v_and_b32_dpp v57, v39, v45 row_newbcast:0 row_mask:0xf bank_mask:0xf
  v_and_b32_dpp v58, v39, v46 row_newbcast:0 row_mask:0xf bank_mask:0xf
  v_and_b32_dpp v59, v39, v47 row_newbcast:0 row_mask:0xf bank_mask:0xf
  s_waitcnt vmcnt(4)
  v_mfma_f32_16x16x32_bf16 v[64:67], v[60:63], v[236:239], v[64:67]
  s_barrier
  v_and_b32_dpp v60, v39, v44 row_newbcast:4 row_mask:0xf bank_mask:0xf
  v_and_b32_dpp v61, v39, v45 row_newbcast:4 row_mask:0xf bank_mask:0xf
  v_and_b32_dpp v62, v39, v46 row_newbcast:4 row_mask:0xf bank_mask:0xf
  v_and_b32_dpp v63, v39, v47 row_newbcast:4 row_mask:0xf bank_mask:0xf
  s_waitcnt vmcnt(3)
  v_mfma_f32_16x16x32_bf16 v[64:67], v[56:59], v[240:243], v[64:67]
  v_and_b32_dpp v56, v39, v44 row_newbcast:8 row_mask:0xf bank_mask:0xf
  v_and_b32_dpp v57, v39, v45 row_newbcast:8 row_mask:0xf bank_mask:0xf
  v_and_b32_dpp v58, v39, v46 row_newbcast:8 row_mask:0xf bank_mask:0xf
  v_and_b32_dpp v59, v39, v47 row_newbcast:8 row_mask:0xf bank_mask:0xf
  s_waitcnt vmcnt(2)
  v_mfma_f32_16x16x32_bf16 v[64:67], v[60:63], v[244:247], v[64:67]
  v_and_b32_dpp v60, v39, v44 row_newbcast:12 row_mask:0xf bank_mask:0xf
  v_and_b32_dpp v61, v39, v45 row_newbcast:12 row_mask:0xf bank_mask:0xf
  v_and_b32_dpp v62, v39, v46 row_newbcast:12 row_mask:0xf bank_mask:0xf
  v_and_b32_dpp v63, v39, v47 row_newbcast:12 row_mask:0xf bank_mask:0xf
  s_waitcnt vmcnt(1)
  v_mfma_f32_16x16x32_bf16 v[64:67], v[56:59], v[248:251], v[64:67]
  s_waitcnt vmcnt(0)
  v_mfma_f32_16x16x32_bf16 v[64:67], v[60:63], v[252:255], v[64:67]
  s_nop 7
  v_pk_mul_f32 v[64:65], v[64:65], v[30:31] op_sel_hi:[1,0]
  v_pk_mul_f32 v[66:67], v[66:67], v[30:31] op_sel_hi:[1,0]
  s_mov_b32 exec_hi, 0
  v_cvt_pk_bf16_f32 v64, v64, v65
  v_cvt_pk_bf16_f32 v65, v66, v67
  ds_write2_b32 v48, v64, v65 offset1:144
  s_waitcnt lgkmcnt(0)
  s_barrier
  s_lshr_b32 s50, s32, 4
  s_or_b32 s50, s50, s31
  s_cbranch_scc1 L_G2_done
  s_mov_b32 exec_hi, -1
  v_lshrrev_b32 v9, 2, v1
  s_lshl_b32 s50, s34, 9
  s_add_u32 s50, s50, 32768
  v_lshl_add_u32 v7, v9, 5, s50
  s_lshl_b32 s50, s34, 5
  s_add_u32 s50, s50, s37
  s_lshl_b32 s50, s50, 12
  s_add_u32 s50, s50, 1048576
  v_add_u32 v8, s50, v10
  v_lshrrev_b32 v9, 1, v6
  v_lshlrev_b32 v9, 3, v9
  v_lshl_add_u32 v9, v3, 1, v9
  v_and_b32 v30, 1, v1
  v_add_u32 v9, v9, v30
  v_lshlrev_b32 v9, 4, v9
  v_add_u32 v9, 154176, v9
  ds_read_b128 v[40:43], v9
  s_waitcnt lgkmcnt(0)
  v_add_f32 v40, v40, v41
  v_add_f32 v42, v42, v43
  v_add_f32 v40, v40, v42
  v_cvt_pk_bf16_f32 v40, v40, v40
  v_and_b32 v40, 0xffff0000, v40
  v_add_f32 v40, v40, v18
  v_cvt_pk_bf16_f32 v40, v40, v40
  v_and_b32 v40, 0xffff0000, v40
  s_mov_b32 s53, 200000
  s_mov_b32 s56, 0x00050005
  s_mov_b32 s57, s56
  s_barrier
L_fpoll:
  global_load_dwordx4 v[128:131], v7, s[28:29] sc1
  global_load_dwordx4 v[132:135], v7, s[28:29] offset:16 sc1
  global_load_dwordx4 v[136:139], v8, s[28:29] offset:0 sc1
  global_load_dwordx4 v[140:143], v8, s[28:29] offset:1024 sc1
  global_load_dwordx4 v[144:147], v8, s[28:29] offset:2048 sc1
  global_load_dwordx4 v[148:151], v8, s[28:29] offset:3072 sc1
  s_mov_b64 exec, -1
  s_sub_u32 s53, s53, 1
  s_cmp_eq_u32 s53, 0
  s_cbranch_scc1 L_fok
  s_waitcnt vmcnt(4)
  v_sub_f32_dpp v20, v128, v128 row_half_mirror row_mask:0xf bank_mask:0xf
  v_sub_f32_dpp v22, v130, v130 row_half_mirror row_mask:0xf bank_mask:0xf
  v_sub_f32_dpp v24, v132, v132 row_half_mirror row_mask:0xf bank_mask:0xf
  v_sub_f32_dpp v26, v134, v134 row_half_mirror row_mask:0xf bank_mask:0xf
  v_xor_b32 v44, s64, v129
  v_xor_b32 v45, s64, v131
  v_xor_b32 v46, s64, v133
  v_xor_b32 v47, s64, v135
  v_exp_f32 v20, v20
  v_exp_f32 v22, v22
  v_exp_f32 v24, v24
  v_exp_f32 v26, v26
  v_or3_b32 v44, v44, v45, v46
  v_or_b32 v44, v44, v47
  v_add_f32 v20, 1.0, v20
  v_add_f32 v22, 1.0, v22
  v_add_f32 v24, 1.0, v24
  v_add_f32 v26, 1.0, v26
  v_cmp_ne_u32 s[54:55], 0, v44
  v_rcp_f32 v20, v20
  v_rcp_f32 v22, v22
  v_rcp_f32 v24, v24
  v_rcp_f32 v26, v26
  s_waitcnt vmcnt(3)
  v_xor_b32 v64, s65, v136
  v_xor_b32 v65, s66, v137
  v_xor_b32 v66, s67, v138
  v_xor_b32 v67, s68, v139
  v_or3_b32 v44, v64, v65, v66
  v_pk_mul_f32 v[32:33], v[64:65], v[20:21] op_sel_hi:[1,0]
  v_pk_mul_f32 v[34:35], v[66:67], v[20:21] op_sel_hi:[1,0]
  v_or_b32 v44, v44, v67
  s_waitcnt vmcnt(2)
  v_xor_b32 v68, s65, v140
  v_xor_b32 v69, s66, v141
  v_xor_b32 v70, s67, v142
  v_xor_b32 v71, s68, v143
  v_pk_fma_f32 v[32:33], v[68:69], v[22:23], v[32:33] op_sel_hi:[1,0,1]
  v_pk_fma_f32 v[34:35], v[70:71], v[22:23], v[34:35] op_sel_hi:[1,0,1]
  v_or3_b32 v44, v44, v68, v69
  v_or3_b32 v44, v44, v70, v71
  s_waitcnt vmcnt(1)
  v_xor_b32 v72, s65, v144
  v_xor_b32 v73, s66, v145
  v_xor_b32 v74, s67, v146
  v_xor_b32 v75, s68, v147
  v_pk_fma_f32 v[32:33], v[72:73], v[24:25], v[32:33] op_sel_hi:[1,0,1]
  v_pk_fma_f32 v[34:35], v[74:75], v[24:25], v[34:35] op_sel_hi:[1,0,1]
  v_or3_b32 v44, v44, v72, v73
  v_or3_b32 v44, v44, v74, v75
  s_waitcnt vmcnt(0)
  v_xor_b32 v76, s65, v148
  v_xor_b32 v77, s66, v149
  v_xor_b32 v78, s67, v150
  v_xor_b32 v79, s68, v151
  v_pk_fma_f32 v[32:33], v[76:77], v[26:27], v[32:33] op_sel_hi:[1,0,1]
  v_pk_fma_f32 v[34:35], v[78:79], v[26:27], v[34:35] op_sel_hi:[1,0,1]
  v_or3_b32 v44, v44, v76, v77
  v_or3_b32 v44, v44, v78, v79
  v_permlane32_swap_b32 v32, v33
  v_permlane32_swap_b32 v34, v35
  v_and_b32 v44, 0x3ff, v44
  v_cmp_ne_u32 vcc, 0, v44
  v_add_f32 v32, v32, v33
  v_add_f32 v34, v34, v35
  s_or_b64 exec, s[54:55], vcc
  s_cbranch_scc1 L_fpoll
  s_mov_b64 exec, -1
L_fok:
  v_permlane16_swap_b32 v32, v34
  v_add_f32 v32, v32, v34
  s_nop 1
  v_add_f32_dpp v32, v32, v32 row_ror:8 row_mask:0xf bank_mask:0xf
  s_nop 1
  v_add_f32_dpp v32, v32, v32 row_ror:4 row_mask:0xf bank_mask:0xf
  v_cvt_pk_bf16_f32 v32, v32, v32
  v_and_b32 v32, 0xffff0000, v32
  v_add_f32 v32, v32, v17
  v_cvt_pk_bf16_f32 v32, v32, v32
  v_and_b32 v32, 0xffff0000, v32
  v_add_f32 v32, v32, v40
  s_nop 1
  v_mov_b32_dpp v33, v32 quad_perm:[1,0,3,2] row_mask:0xf bank_mask:0xf
  v_cvt_pk_bf16_f32 v32, v32, v33
  s_mov_b64 exec, s[56:57]
  global_store_dword v15, v32, s[24:25]
  s_cmp_lg_u32 s2, 0
  s_cbranch_scc1 L_G2_done
  s_mov_b64 exec, 1
  v_mov_b32 v7, 0
  v_mov_b32 v8, s64
  global_store_dword v7, v8, s[28:29] offset:0
L_G2_done:
L_end:
  s_endpgm
L_G1B:
  buffer_load_dwordx4 v[152:155], v10, s[40:43], s50 offen offset:2048 nt
  buffer_load_dwordx4 v[156:159], v10, s[40:43], s50 offen offset:3072 nt
  buffer_load_dwordx4 v12, s[44:47], s48 offen nt lds
  s_addk_i32 s48, 0x1000
  s_addk_i32 m0, 0x400
  s_addk_i32 s36, 0x4000
  s_and_b32 s50, s36, s39
  s_or_b32 s50, s50, s35
  buffer_load_dwordx4 v[160:163], v10, s[40:43], s50 offen offset:0 nt
  buffer_load_dwordx4 v[164:167], v10, s[40:43], s50 offen offset:1024 nt
  buffer_load_dwordx4 v11, s[44:47], s48 offen nt lds
  s_addk_i32 s48, 0x1000
  s_addk_i32 m0, 0x400
  buffer_load_dwordx4 v[168:171], v10, s[40:43], s50 offen offset:2048 nt
  buffer_load_dwordx4 v[172:175], v10, s[40:43], s50 offen offset:3072 nt
  buffer_load_dwordx4 v11, s[44:47], s48 offen nt lds
  s_addk_i32 s48, 0x1000
  s_addk_i32 m0, 0x400
  s_addk_i32 s36, 0x4000
  s_and_b32 s50, s36, s39
  s_or_b32 s50, s50, s35
  buffer_load_dwordx4 v[176:179], v10, s[40:43], s50 offen offset:0 nt
  buffer_load_dwordx4 v12, s[44:47], s48 offen nt lds
  s_addk_i32 s48, 0x1000
  s_addk_i32 m0, 0x400
  buffer_load_dwordx4 v[180:183], v10, s[40:43], s50 offen offset:1024 nt
  buffer_load_dwordx4 v[184:187], v10, s[40:43], s50 offen offset:2048 nt
  buffer_load_dwordx4 v12, s[44:47], s48 offen nt lds
  s_addk_i32 s48, 0x1000
  s_addk_i32 m0, 0x400
  buffer_load_dwordx4 v[188:191], v10, s[40:43], s50 offen offset:3072 nt
  s_addk_i32 s36, 0x4000
  s_and_b32 s50, s36, s39
  s_or_b32 s50, s50, s35
  buffer_load_dwordx4 v[192:195], v10, s[40:43], s50 offen offset:0 nt
  buffer_load_dwordx4 v11, s[44:47], s48 offen nt lds
  s_addk_i32 s48, 0x1000
  s_addk_i32 m0, 0x400
  buffer_load_dwordx4 v[196:199], v10, s[40:43], s50 offen offset:1024 nt
  buffer_load_dwordx4 v[200:203], v10, s[40:43], s50 offen offset:2048 nt
  buffer_load_dwordx4 v11, s[44:47], s48 offen nt lds
  s_addk_i32 s48, 0x1000
  s_addk_i32 m0, 0x400
  buffer_load_dwordx4 v[204:207], v10, s[40:43], s50 offen offset:3072 nt
  s_addk_i32 s36, 0x4000
  s_and_b32 s50, s36, s39
  s_or_b32 s50, s50, s35
  buffer_load_dwordx4 v[208:211], v10, s[40:43], s50 offen offset:0 nt
  buffer_load_dwordx4 v12, s[44:47], s48 offen nt lds
  s_addk_i32 s48, 0x1000
  s_addk_i32 m0, 0x400
  buffer_load_dwordx4 v[212:215], v10, s[40:43], s50 offen offset:1024 nt
  buffer_load_dwordx4 v12, s[44:47], s48 offen nt lds
  s_addk_i32 s48, 0x1000
  s_addk_i32 m0, 0x400
  buffer_load_dwordx4 v[216:219], v10, s[40:43], s50 offen offset:2048 nt
  buffer_load_dwordx4 v[220:223], v10, s[40:43], s50 offen offset:3072 nt
  buffer_load_dwordx4 v11, s[44:47], s48 offen nt lds
  s_addk_i32 s48, 0x1000
  s_addk_i32 m0, 0x400
  s_addk_i32 s36, 0x4000
  s_and_b32 s50, s36, s39
  s_or_b32 s50, s50, s35
  buffer_load_dwordx4 v[224:227], v10, s[40:43], s50 offen offset:0 nt
  buffer_load_dwordx4 v[228:231], v10, s[40:43], s50 offen offset:1024 nt
  buffer_load_dwordx4 v11, s[44:47], s48 offen nt lds
  s_addk_i32 s48, 0x1000
  s_addk_i32 m0, 0x400
  buffer_load_dwordx4 v[232:235], v10, s[40:43], s50 offen offset:2048 nt
  buffer_load_dwordx4 v[236:239], v10, s[40:43], s50 offen offset:3072 nt
  buffer_load_dwordx4 v12, s[44:47], s48 offen nt lds
  s_addk_i32 s48, 0x1000
  s_addk_i32 m0, 0x400
  s_addk_i32 s36, 0x4000
  s_and_b32 s50, s36, s39
  s_or_b32 s50, s50, s35
  buffer_load_dwordx4 v[240:243], v10, s[40:43], s50 offen offset:0 nt
  buffer_load_dwordx4 v[244:247], v10, s[40:43], s50 offen offset:1024 nt
  buffer_load_dwordx4 v12, s[44:47], s48 offen nt lds
  s_addk_i32 s48, 0x1000
  s_addk_i32 m0, 0x400
  buffer_load_dwordx4 v[248:251], v10, s[40:43], s50 offen offset:2048 nt
  buffer_load_dwordx4 v[252:255], v10, s[40:43], s50 offen offset:3072 nt
  buffer_load_dwordx4 v11, s[44:47], s48 offen nt lds
  s_addk_i32 s48, 0x1000
  s_addk_i32 m0, 0x400
  v_mul_u32_u24 v16, 12, v1
  s_mul_i32 s52, s31, 688
  v_add_u32 v16, s52, v16
  s_add_u32 s54, s52, 688
  s_mov_b32 s55, s43
  s_mov_b32 s58, s54
  s_mov_b32 s59, s43
  s_mov_b32 s62, s54
  s_mov_b32 s63, s43
  s_mov_b64 s[52:53], s[16:17]
  s_mov_b64 s[56:57], s[18:19]
  s_mov_b64 s[60:61], s[20:21]
  buffer_load_dwordx3 v[112:114], v16, s[52:55], 0 offen
  buffer_load_dwordx3 v[116:118], v16, s[56:59], 0 offen
  buffer_load_dwordx3 v[120:122], v16, s[60:63], 0 offen
  v_lshlrev_b32 v13, 6, v3
  v_lshl_add_u32 v13, v6, 4, v13
  v_add_u32 v13, 152576, v13
  v_mov_b32 v14, 154432
  s_mov_b32 s70, 0xf000f
  s_mov_b32 s71, s70
  s_mov_b32 s72, 0xf000f0
  s_mov_b32 s73, s72
  s_mov_b32 s74, 0xf000f00
  s_mov_b32 s75, s74
  s_mov_b32 s76, 0xf000f000
  s_mov_b32 s77, s76
  s_barrier
  ds_read_b128 v[16:19], v13
  ds_read_b32 v14, v14
  s_waitcnt lgkmcnt(0)
  v_readfirstlane_b32 s64, v14
  v_cndmask_b32 v96, 0, v16, s[70:71]
  v_cndmask_b32 v97, 0, v17, s[70:71]
  v_cndmask_b32 v98, 0, v18, s[70:71]
  v_cndmask_b32 v99, 0, v19, s[70:71]
  v_cndmask_b32 v100, 0, v16, s[72:73]
  v_cndmask_b32 v101, 0, v17, s[72:73]
  v_cndmask_b32 v102, 0, v18, s[72:73]
  v_cndmask_b32 v103, 0, v19, s[72:73]
  v_cndmask_b32 v104, 0, v16, s[74:75]
  v_cndmask_b32 v105, 0, v17, s[74:75]
  v_cndmask_b32 v106, 0, v18, s[74:75]
  v_cndmask_b32 v107, 0, v19, s[74:75]
  v_cndmask_b32 v108, 0, v16, s[76:77]
  v_cndmask_b32 v109, 0, v17, s[76:77]
  v_cndmask_b32 v110, 0, v18, s[76:77]
  v_cndmask_b32 v111, 0, v19, s[76:77]
  s_and_b32 s65, s64, 0x3ff
  s_bfe_u32 s66, s64, 0xa000a
  s_bfe_u32 s67, s64, 0xa0014
  s_xor_b32 s68, s65, 0x154
  s_and_b32 s68, s68, 0x3fc
  s_lshr_b32 s69, s64, 30
  s_or_b32 s68, s68, s69
  s_waitcnt vmcnt(47)
  v_mfma_f32_16x16x32_bf16 v[64:67], v[128:131], v[96:99], 0
  v_mfma_f32_16x16x32_bf16 v[64:67], v[132:135], v[100:103], v[64:67]
  v_mfma_f32_16x16x32_bf16 v[64:67], v[136:139], v[104:107], v[64:67]
  v_mfma_f32_16x16x32_bf16 v[64:67], v[140:143], v[108:111], v[64:67]
  s_waitcnt vmcnt(41)
  v_mfma_f32_16x16x32_bf16 v[68:71], v[144:147], v[96:99], 0
  v_mfma_f32_16x16x32_bf16 v[68:71], v[148:151], v[100:103], v[68:71]
  v_mfma_f32_16x16x32_bf16 v[68:71], v[152:155], v[104:107], v[68:71]
  v_mfma_f32_16x16x32_bf16 v[68:71], v[156:159], v[108:111], v[68:71]
  s_waitcnt vmcnt(35)
  v_mfma_f32_16x16x32_bf16 v[72:75], v[160:163], v[96:99], 0
  v_mfma_f32_16x16x32_bf16 v[72:75], v[164:167], v[100:103], v[72:75]
  v_mfma_f32_16x16x32_bf16 v[72:75], v[168:171], v[104:107], v[72:75]
  v_mfma_f32_16x16x32_bf16 v[72:75], v[172:175], v[108:111], v[72:75]
  s_waitcnt vmcnt(33)
  v_mfma_f32_16x16x32_bf16 v[76:79], v[176:179], v[96:99], 0
  s_waitcnt vmcnt(31)
  v_mfma_f32_16x16x32_bf16 v[76:79], v[180:183], v[100:103], v[76:79]
  s_waitcnt vmcnt(30)
  v_mfma_f32_16x16x32_bf16 v[76:79], v[184:187], v[104:107], v[76:79]
  s_waitcnt vmcnt(28)
  v_mfma_f32_16x16x32_bf16 v[76:79], v[188:191], v[108:111], v[76:79]
  s_waitcnt vmcnt(27)
  v_mfma_f32_16x16x32_bf16 v[80:83], v[192:195], v[96:99], 0
  s_waitcnt vmcnt(25)
  v_mfma_f32_16x16x32_bf16 v[80:83], v[196:199], v[100:103], v[80:83]
  s_waitcnt vmcnt(24)
  v_mfma_f32_16x16x32_bf16 v[80:83], v[200:203], v[104:107], v[80:83]
  s_waitcnt vmcnt(22)
  v_mfma_f32_16x16x32_bf16 v[80:83], v[204:207], v[108:111], v[80:83]
  s_waitcnt vmcnt(21)
  v_mfma_f32_16x16x32_bf16 v[84:87], v[208:211], v[96:99], 0
  s_waitcnt vmcnt(19)
  v_mfma_f32_16x16x32_bf16 v[84:87], v[212:215], v[100:103], v[84:87]
  s_waitcnt vmcnt(17)
  v_mfma_f32_16x16x32_bf16 v[84:87], v[216:219], v[104:107], v[84:87]
  s_waitcnt vmcnt(16)
  v_mfma_f32_16x16x32_bf16 v[84:87], v[220:223], v[108:111], v[84:87]
  s_waitcnt vmcnt(14)
  v_mfma_f32_16x16x32_bf16 v[88:91], v[224:227], v[96:99], 0
  s_waitcnt vmcnt(13)
  v_mfma_f32_16x16x32_bf16 v[88:91], v[228:231], v[100:103], v[88:91]
  s_waitcnt vmcnt(11)
  v_mfma_f32_16x16x32_bf16 v[88:91], v[232:235], v[104:107], v[88:91]
  s_waitcnt vmcnt(10)
  v_mfma_f32_16x16x32_bf16 v[88:91], v[236:239], v[108:111], v[88:91]
  s_waitcnt vmcnt(8)
  v_mfma_f32_16x16x32_bf16 v[92:95], v[240:243], v[96:99], 0
  s_waitcnt vmcnt(7)
  v_mfma_f32_16x16x32_bf16 v[92:95], v[244:247], v[100:103], v[92:95]
  s_waitcnt vmcnt(5)
  v_mfma_f32_16x16x32_bf16 v[92:95], v[248:251], v[104:107], v[92:95]
  s_waitcnt vmcnt(4)
  v_mfma_f32_16x16x32_bf16 v[92:95], v[252:255], v[108:111], v[92:95]
  v_mov_b32_dpp v20, v64 quad_perm:[0,0,0,0] row_mask:0xf bank_mask:0xf
  v_mov_b32_dpp v21, v68 quad_perm:[0,0,0,0] row_mask:0xf bank_mask:0xf
  v_mov_b32_dpp v22, v72 quad_perm:[0,0,0,0] row_mask:0xf bank_mask:0xf
  v_mov_b32_dpp v23, v76 quad_perm:[0,0,0,0] row_mask:0xf bank_mask:0xf
  v_mov_b32_dpp v24, v80 quad_perm:[0,0,0,0] row_mask:0xf bank_mask:0xf
  v_mov_b32_dpp v25, v84 quad_perm:[0,0,0,0] row_mask:0xf bank_mask:0xf
  v_mov_b32_dpp v26, v88 quad_perm:[0,0,0,0] row_mask:0xf bank_mask:0xf
  s_nop 0
  v_mov_b32_dpp v27, v92 quad_perm:[0,0,0,0] row_mask:0xf bank_mask:0xf
  v_add_f32_dpp v20, v65, v20 quad_perm:[1,1,1,1] row_mask:0xf bank_mask:0xf
  v_add_f32_dpp v21, v69, v21 quad_perm:[1,1,1,1] row_mask:0xf bank_mask:0xf
  v_add_f32_dpp v22, v73, v22 quad_perm:[1,1,1,1] row_mask:0xf bank_mask:0xf
  v_add_f32_dpp v23, v77, v23 quad_perm:[1,1,1,1] row_mask:0xf bank_mask:0xf
  v_add_f32_dpp v24, v81, v24 quad_perm:[1,1,1,1] row_mask:0xf bank_mask:0xf
  v_add_f32_dpp v25, v85, v25 quad_perm:[1,1,1,1] row_mask:0xf bank_mask:0xf
  v_add_f32_dpp v26, v89, v26 quad_perm:[1,1,1,1] row_mask:0xf bank_mask:0xf
  v_add_f32_dpp v27, v93, v27 quad_perm:[1,1,1,1] row_mask:0xf bank_mask:0xf
  v_add_f32_dpp v20, v66, v20 quad_perm:[2,2,2,2] row_mask:0xf bank_mask:0xf
  v_add_f32_dpp v21, v70, v21 quad_perm:[2,2,2,2] row_mask:0xf bank_mask:0xf
  v_add_f32_dpp v22, v74, v22 quad_perm:[2,2,2,2] row_mask:0xf bank_mask:0xf
  v_add_f32_dpp v23, v78, v23 quad_perm:[2,2,2,2] row_mask:0xf bank_mask:0xf
  v_add_f32_dpp v24, v82, v24 quad_perm:[2,2,2,2] row_mask:0xf bank_mask:0xf
  v_add_f32_dpp v25, v86, v25 quad_perm:[2,2,2,2] row_mask:0xf bank_mask:0xf
  v_add_f32_dpp v26, v90, v26 quad_perm:[2,2,2,2] row_mask:0xf bank_mask:0xf
  v_add_f32_dpp v27, v94, v27 quad_perm:[2,2,2,2] row_mask:0xf bank_mask:0xf
  v_add_f32_dpp v20, v67, v20 quad_perm:[3,3,3,3] row_mask:0xf bank_mask:0xf
  v_add_f32_dpp v21, v71, v21 quad_perm:[3,3,3,3] row_mask:0xf bank_mask:0xf
  v_add_f32_dpp v22, v75, v22 quad_perm:[3,3,3,3] row_mask:0xf bank_mask:0xf
  v_add_f32_dpp v23, v79, v23 quad_perm:[3,3,3,3] row_mask:0xf bank_mask:0xf
  v_add_f32_dpp v24, v83, v24 quad_perm:[3,3,3,3] row_mask:0xf bank_mask:0xf
  v_add_f32_dpp v25, v87, v25 quad_perm:[3,3,3,3] row_mask:0xf bank_mask:0xf
  v_add_f32_dpp v26, v91, v26 quad_perm:[3,3,3,3] row_mask:0xf bank_mask:0xf
  v_add_f32_dpp v27, v95, v27 quad_perm:[3,3,3,3] row_mask:0xf bank_mask:0xf
  v_cvt_pk_bf16_f32 v28, v20, v21
  v_cvt_pk_bf16_f32 v29, v22, v23
  v_cvt_pk_bf16_f32 v30, v24, v25
  v_cvt_pk_bf16_f32 v31, v26, v27
  v_lshlrev_b32 v20, 16, v28
  v_and_b32 v21, 0xffff0000, v28
  v_lshlrev_b32 v22, 16, v29
  v_and_b32 v23, 0xffff0000, v29
  v_lshlrev_b32 v24, 16, v30
  v_and_b32 v25, 0xffff0000, v30
  v_lshlrev_b32 v26, 16, v31
  v_and_b32 v27, 0xffff0000, v31
  s_mov_b32 s70, 0x3db504f3
  s_mov_b32 s72, 0x3fb8aa3b
  v_pk_mul_f32 v[20:21], v[20:21], s[70:71] op_sel_hi:[1,0]
  v_pk_mul_f32 v[22:23], v[22:23], s[70:71] op_sel_hi:[1,0]
  v_pk_mul_f32 v[24:25], v[24:25], s[70:71] op_sel_hi:[1,0]
  v_pk_mul_f32 v[26:27], v[26:27], s[70:71] op_sel_hi:[1,0]
  v_cvt_pk_bf16_f32 v28, v20, v21
  v_cvt_pk_bf16_f32 v29, v22, v23
  v_cvt_pk_bf16_f32 v30, v24, v25
  v_cvt_pk_bf16_f32 v31, v26, v27
  v_lshlrev_b32 v20, 16, v28
  v_and_b32 v21, 0xffff0000, v28
  v_lshlrev_b32 v22, 16, v29
  v_and_b32 v23, 0xffff0000, v29
  v_lshlrev_b32 v24, 16, v30
  v_and_b32 v25, 0xffff0000, v30
  v_lshlrev_b32 v26, 16, v31
  v_and_b32 v27, 0xffff0000, v31
  v_max3_f32 v32, v20, v21, v22
  v_max3_f32 v33, v23, v24, v25
  v_max3_f32 v32, v32, v26, v27
  v_max_f32 v32, v32, v33
  s_nop 1
  v_max_f32_dpp v32, v32, v32 row_ror:4 row_mask:0xf bank_mask:0xf
  s_nop 1
  v_max_f32_dpp v32, v32, v32 row_ror:8 row_mask:0xf bank_mask:0xf
  v_mov_b32 v33, v32
  s_nop 1
  v_permlane16_swap_b32 v33, v32
  v_max_f32 v32, v32, v33
  v_mov_b32 v33, v32
  s_nop 1
  v_permlane32_swap_b32 v33, v32
  v_max_f32 v32, v32, v33
  v_mul_f32 v32, s72, v32
  v_fma_f32 v20, v20, s72, -v32
  v_fma_f32 v21, v21, s72, -v32
  v_fma_f32 v22, v22, s72, -v32
  v_fma_f32 v23, v23, s72, -v32
  v_fma_f32 v24, v24, s72, -v32
  v_fma_f32 v25, v25, s72, -v32
  v_fma_f32 v26, v26, s72, -v32
  v_fma_f32 v27, v27, s72, -v32
  v_exp_f32 v20, v20
  v_exp_f32 v21, v21
  v_exp_f32 v22, v22
  v_exp_f32 v23, v23
  v_exp_f32 v24, v24
  v_exp_f32 v25, v25
  v_exp_f32 v26, v26
  v_exp_f32 v27, v27
  v_pk_add_f32 v[34:35], v[20:21], v[22:23]
  v_pk_add_f32 v[36:37], v[24:25], v[26:27]
  v_pk_add_f32 v[34:35], v[34:35], v[36:37]
  v_add_f32 v33, v34, v35
  v_cvt_pk_bf16_f32 v20, v20, v20
  v_cvt_pk_bf16_f32 v21, v21, v21
  v_cvt_pk_bf16_f32 v22, v22, v22
  v_cvt_pk_bf16_f32 v23, v23, v23
  v_cvt_pk_bf16_f32 v24, v24, v24
  v_cvt_pk_bf16_f32 v25, v25, v25
  v_cvt_pk_bf16_f32 v26, v26, v26
  v_cvt_pk_bf16_f32 v27, v27, v27
  v_add_f32_dpp v33, v33, v33 row_ror:4 row_mask:0xf bank_mask:0xf
  s_nop 1
  v_add_f32_dpp v33, v33, v33 row_ror:8 row_mask:0xf bank_mask:0xf
  v_mov_b32 v34, v33
  s_nop 1
  v_permlane16_swap_b32 v34, v33
  v_add_f32 v33, v33, v34
  v_mov_b32 v34, v33
  s_nop 1
  v_permlane32_swap_b32 v34, v33
  v_add_f32 v33, v33, v34
  s_lshl_b32 s50, s31, 11
  s_add_u32 s50, s50, 131072
  v_lshl_add_u32 v14, v1, 4, s50
  ds_write_b128 v14, v[20:23]
  ds_write_b128 v14, v[24:27] offset:1024
  v_mov_b32 v14, 154128
  v_lshl_add_u32 v14, s31, 3, v14
  ds_write_b64 v14, v[32:33]
  v_and_b32 v7, 1, v3
  v_lshl_add_u32 v7, v7, 2, v5
  v_lshlrev_b32 v7, 5, v7
  v_lshl_add_u32 v7, v6, 3, v7
  v_lshl_add_u32 v7, v5, 8, v7
  v_lshl_add_u32 v7, v3, 11, v7
  v_add_u32 v40, s49, v7
  v_xor_b32 v41, 32, v40
  v_xor_b32 v42, 64, v40
  v_xor_b32 v43, 96, v40
  v_xor_b32 v44, 128, v40
  v_xor_b32 v45, 160, v40
  v_xor_b32 v46, 192, v40
  v_xor_b32 v47, 224, v40
  v_min_u32 v8, 8, v4
  v_subrev_u32 v9, 8, v4
  v_min_u32 v9, 8, v9
  v_mul_u32_u24 v8, 144, v8
  v_mul_u32_u24 v9, 144, v9
  v_mov_b32 v39, 0x4444
  v_and_b32 v38, 1, v5
  v_mul_u32_u24 v38, 0xaaaa, v38
  v_add_u32 v39, v39, v38
  v_lshlrev_b32 v7, 4, v3
  v_add_u32 v7, 152832, v7
  v_add_u32 v48, v7, v8
  v_add_u32 v49, v7, v9
  v_lshrrev_b32 v7, 1, v3
  v_lshl_add_u32 v7, v7, 2, v5
  v_lshlrev_b32 v7, 12, v7
  v_lshl_add_u32 v7, v6, 4, v7
  s_lshl_b32 s50, s34, 17
  s_add_u32 s50, s50, s49
  s_lshl_b32 s51, s37, 6
  s_add_u32 s50, s50, s51
  s_add_u32 s50, s50, 1048576
  v_add_u32 v50, s50, v7
  v_mov_b32 v51, 0xfffffc00
  s_and_b32 s50, s37, 15
  s_lshr_b32 s51, s37, 4
  s_lshl2_add_u32 s50, s50, s51
  s_lshl_b32 s51, s34, 6
  s_add_u32 s50, s50, s51
  s_lshl_b32 s50, s50, 3
  s_add_u32 s50, s50, 32768
  v_mov_b32 v15, s50
  v_mov_b32 v37, s64
  s_waitcnt vmcnt(0)
  s_cmp_ge_u32 s32, 16
  s_cbranch_scc1 L_nomlp
  v_and_b32 v8, 1, v3
  v_lshlrev_b32 v8, 5, v8
  v_lshrrev_b32 v9, 1, v3
  v_lshl_add_u32 v8, v9, 4, v8
  v_bfe_u32 v9, v1, 3, 1
  v_add_u32 v8, v8, v9
  s_bfe_u32 s50, s37, 0x30002
  s_lshl_b32 s50, s50, 6
  s_and_b32 s51, s37, 3
  s_lshl2_add_u32 s50, s51, s50
  v_add_u32 v8, s50, v8
  v_lshlrev_b32 v8, 1, v8
  v_add_u32 v8, 151552, v8
  v_lshrrev_b32 v9, 3, v1
  v_lshlrev_b32 v9, 4, v9
  s_lshl_b32 s50, s31, 2
  s_add_u32 s50, s50, 154176
  v_add_u32 v9, s50, v9
  v_lshlrev_b32 v64, 16, v112
  v_and_b32 v65, 0xffff0000, v112
  v_lshlrev_b32 v66, 16, v113
  v_and_b32 v67, 0xffff0000, v113
  v_lshlrev_b32 v68, 16, v114
  v_and_b32 v69, 0xffff0000, v114
  v_lshlrev_b32 v74, 16, v116
  v_and_b32 v75, 0xffff0000, v116
  v_lshlrev_b32 v76, 16, v117
  v_and_b32 v77, 0xffff0000, v117
  v_lshlrev_b32 v78, 16, v118
  v_and_b32 v79, 0xffff0000, v118
  v_lshlrev_b32 v80, 16, v120
  v_and_b32 v81, 0xffff0000, v120
  v_lshlrev_b32 v82, 16, v121
  v_and_b32 v83, 0xffff0000, v121
  v_lshlrev_b32 v84, 16, v122
  v_and_b32 v85, 0xffff0000, v122
  s_mov_b32 s82, 0xbdd2d3e8
  v_mov_b32 v86, 0xc0135761
  s_mov_b32 s51, 0
L_mlp:
  ds_read_u16 v72, v8
  v_add_u32 v8, 4, v8
  s_waitcnt lgkmcnt(0)
  v_lshlrev_b32 v72, 16, v72
  s_nop 0
  v_readlane_b32 s74, v72, 0
  v_readlane_b32 s75, v72, 32
  v_readlane_b32 s76, v72, 16
  v_readlane_b32 s77, v72, 48
  v_readlane_b32 s78, v72, 8
  v_readlane_b32 s79, v72, 40
  v_readlane_b32 s80, v72, 24
  v_readlane_b32 s81, v72, 56
  v_pk_mul_f32 v[88:89], v[64:65], s[74:75] op_sel:[0,0] op_sel_hi:[1,0]
  v_pk_mul_f32 v[90:91], v[66:67], s[74:75] op_sel:[0,0] op_sel_hi:[1,0]
  v_pk_mul_f32 v[92:93], v[68:69], s[74:75] op_sel:[0,0] op_sel_hi:[1,0]
  v_cvt_pk_bf16_f32 v104, v88, v89
  v_cvt_pk_bf16_f32 v105, v90, v91
  v_cvt_pk_bf16_f32 v106, v92, v93
  v_lshlrev_b32 v88, 16, v104
  v_and_b32 v89, 0xffff0000, v104
  v_lshlrev_b32 v90, 16, v105
  v_and_b32 v91, 0xffff0000, v105
  v_lshlrev_b32 v92, 16, v106
  v_and_b32 v93, 0xffff0000, v106
  v_pk_add_f32 v[88:89], v[88:89], v[74:75]
  v_pk_add_f32 v[90:91], v[90:91], v[76:77]
  v_pk_add_f32 v[92:93], v[92:93], v[78:79]
  v_cvt_pk_bf16_f32 v104, v88, v89
  v_cvt_pk_bf16_f32 v105, v90, v91
  v_cvt_pk_bf16_f32 v106, v92, v93
  v_lshlrev_b32 v88, 16, v104
  v_and_b32 v89, 0xffff0000, v104
  v_lshlrev_b32 v90, 16, v105
  v_and_b32 v91, 0xffff0000, v105
  v_lshlrev_b32 v92, 16, v106
  v_and_b32 v93, 0xffff0000, v106
  v_pk_mul_f32 v[96:97], v[88:89], v[88:89]
  v_pk_mul_f32 v[98:99], v[90:91], v[90:91]
  v_pk_mul_f32 v[100:101], v[92:93], v[92:93]
  v_pk_fma_f32 v[96:97], v[96:97], s[82:83], v[86:87] op_sel_hi:[1,0,0]
  v_pk_fma_f32 v[98:99], v[98:99], s[82:83], v[86:87] op_sel_hi:[1,0,0]
  v_pk_fma_f32 v[100:101], v[100:101], s[82:83], v[86:87] op_sel_hi:[1,0,0]
  v_pk_mul_f32 v[96:97], v[96:97], v[88:89]
  v_pk_mul_f32 v[98:99], v[98:99], v[90:91]
  v_pk_mul_f32 v[100:101], v[100:101], v[92:93]
  v_exp_f32 v96, v96
  v_exp_f32 v97, v97
  v_exp_f32 v98, v98
  v_exp_f32 v99, v99
  v_exp_f32 v100, v100
  v_exp_f32 v101, v101
  v_pk_add_f32 v[96:97], v[96:97], 1.0 op_sel_hi:[1,0]
  v_pk_add_f32 v[98:99], v[98:99], 1.0 op_sel_hi:[1,0]
  v_pk_add_f32 v[100:101], v[100:101], 1.0 op_sel_hi:[1,0]
  v_rcp_f32 v96, v96
  v_rcp_f32 v97, v97
  v_rcp_f32 v98, v98
  v_rcp_f32 v99, v99
  v_rcp_f32 v100, v100
  v_rcp_f32 v101, v101
  v_pk_mul_f32 v[88:89], v[88:89], v[96:97]
  v_pk_mul_f32 v[90:91], v[90:91], v[98:99]
  v_pk_mul_f32 v[92:93], v[92:93], v[100:101]
  v_cvt_pk_bf16_f32 v104, v88, v89
  v_cvt_pk_bf16_f32 v105, v90, v91
  v_cvt_pk_bf16_f32 v106, v92, v93
  v_dot2_f32_bf16 v20, v104, v120, 0
  v_dot2_f32_bf16 v20, v105, v121, v20
  v_dot2_f32_bf16 v20, v106, v122, v20
  v_pk_mul_f32 v[88:89], v[64:65], s[74:75] op_sel:[0,1] op_sel_hi:[1,1]
  v_pk_mul_f32 v[90:91], v[66:67], s[74:75] op_sel:[0,1] op_sel_hi:[1,1]
  v_pk_mul_f32 v[92:93], v[68:69], s[74:75] op_sel:[0,1] op_sel_hi:[1,1]
  v_cvt_pk_bf16_f32 v104, v88, v89
  v_cvt_pk_bf16_f32 v105, v90, v91
  v_cvt_pk_bf16_f32 v106, v92, v93
  v_lshlrev_b32 v88, 16, v104
  v_and_b32 v89, 0xffff0000, v104
  v_lshlrev_b32 v90, 16, v105
  v_and_b32 v91, 0xffff0000, v105
  v_lshlrev_b32 v92, 16, v106
  v_and_b32 v93, 0xffff0000, v106
  v_pk_add_f32 v[88:89], v[88:89], v[74:75]
  v_pk_add_f32 v[90:91], v[90:91], v[76:77]
  v_pk_add_f32 v[92:93], v[92:93], v[78:79]
  v_cvt_pk_bf16_f32 v104, v88, v89
  v_cvt_pk_bf16_f32 v105, v90, v91
  v_cvt_pk_bf16_f32 v106, v92, v93
  v_lshlrev_b32 v88, 16, v104
  v_and_b32 v89, 0xffff0000, v104
  v_lshlrev_b32 v90, 16, v105
  v_and_b32 v91, 0xffff0000, v105
  v_lshlrev_b32 v92, 16, v106
  v_and_b32 v93, 0xffff0000, v106
  v_pk_mul_f32 v[96:97], v[88:89], v[88:89]
  v_pk_mul_f32 v[98:99], v[90:91], v[90:91]
  v_pk_mul_f32 v[100:101], v[92:93], v[92:93]
  v_pk_fma_f32 v[96:97], v[96:97], s[82:83], v[86:87] op_sel_hi:[1,0,0]
  v_pk_fma_f32 v[98:99], v[98:99], s[82:83], v[86:87] op_sel_hi:[1,0,0]
  v_pk_fma_f32 v[100:101], v[100:101], s[82:83], v[86:87] op_sel_hi:[1,0,0]
  v_pk_mul_f32 v[96:97], v[96:97], v[88:89]
  v_pk_mul_f32 v[98:99], v[98:99], v[90:91]
  v_pk_mul_f32 v[100:101], v[100:101], v[92:93]
  v_exp_f32 v96, v96
  v_exp_f32 v97, v97
  v_exp_f32 v98, v98
  v_exp_f32 v99, v99
  v_exp_f32 v100, v100
  v_exp_f32 v101, v101
  v_pk_add_f32 v[96:97], v[96:97], 1.0 op_sel_hi:[1,0]
  v_pk_add_f32 v[98:99], v[98:99], 1.0 op_sel_hi:[1,0]
  v_pk_add_f32 v[100:101], v[100:101], 1.0 op_sel_hi:[1,0]
  v_rcp_f32 v96, v96
  v_rcp_f32 v97, v97
  v_rcp_f32 v98, v98
  v_rcp_f32 v99, v99
  v_rcp_f32 v100, v100
  v_rcp_f32 v101, v101
  v_pk_mul_f32 v[88:89], v[88:89], v[96:97]
  v_pk_mul_f32 v[90:91], v[90:91], v[98:99]
  v_pk_mul_f32 v[92:93], v[92:93], v[100:101]
  v_cvt_pk_bf16_f32 v104, v88, v89
  v_cvt_pk_bf16_f32 v105, v90, v91
  v_cvt_pk_bf16_f32 v106, v92, v93
  v_dot2_f32_bf16 v21, v104, v120, 0
  v_dot2_f32_bf16 v21, v105, v121, v21
  v_dot2_f32_bf16 v21, v106, v122, v21
  v_pk_mul_f32 v[88:89], v[64:65], s[76:77] op_sel:[0,0] op_sel_hi:[1,0]
  v_pk_mul_f32 v[90:91], v[66:67], s[76:77] op_sel:[0,0] op_sel_hi:[1,0]
  v_pk_mul_f32 v[92:93], v[68:69], s[76:77] op_sel:[0,0] op_sel_hi:[1,0]
  v_cvt_pk_bf16_f32 v104, v88, v89
  v_cvt_pk_bf16_f32 v105, v90, v91
  v_cvt_pk_bf16_f32 v106, v92, v93
  v_lshlrev_b32 v88, 16, v104
  v_and_b32 v89, 0xffff0000, v104
  v_lshlrev_b32 v90, 16, v105
  v_and_b32 v91, 0xffff0000, v105
  v_lshlrev_b32 v92, 16, v106
  v_and_b32 v93, 0xffff0000, v106
  v_pk_add_f32 v[88:89], v[88:89], v[74:75]
  v_pk_add_f32 v[90:91], v[90:91], v[76:77]
  v_pk_add_f32 v[92:93], v[92:93], v[78:79]
  v_cvt_pk_bf16_f32 v104, v88, v89
  v_cvt_pk_bf16_f32 v105, v90, v91
  v_cvt_pk_bf16_f32 v106, v92, v93
  v_lshlrev_b32 v88, 16, v104
  v_and_b32 v89, 0xffff0000, v104
  v_lshlrev_b32 v90, 16, v105
  v_and_b32 v91, 0xffff0000, v105
  v_lshlrev_b32 v92, 16, v106
  v_and_b32 v93, 0xffff0000, v106
  v_pk_mul_f32 v[96:97], v[88:89], v[88:89]
  v_pk_mul_f32 v[98:99], v[90:91], v[90:91]
  v_pk_mul_f32 v[100:101], v[92:93], v[92:93]
  v_pk_fma_f32 v[96:97], v[96:97], s[82:83], v[86:87] op_sel_hi:[1,0,0]
  v_pk_fma_f32 v[98:99], v[98:99], s[82:83], v[86:87] op_sel_hi:[1,0,0]
  v_pk_fma_f32 v[100:101], v[100:101], s[82:83], v[86:87] op_sel_hi:[1,0,0]
  v_pk_mul_f32 v[96:97], v[96:97], v[88:89]
  v_pk_mul_f32 v[98:99], v[98:99], v[90:91]
  v_pk_mul_f32 v[100:101], v[100:101], v[92:93]
  v_exp_f32 v96, v96
  v_exp_f32 v97, v97
  v_exp_f32 v98, v98
  v_exp_f32 v99, v99
  v_exp_f32 v100, v100
  v_exp_f32 v101, v101
  v_pk_add_f32 v[96:97], v[96:97], 1.0 op_sel_hi:[1,0]
  v_pk_add_f32 v[98:99], v[98:99], 1.0 op_sel_hi:[1,0]
  v_pk_add_f32 v[100:101], v[100:101], 1.0 op_sel_hi:[1,0]
  v_rcp_f32 v96, v96
  v_rcp_f32 v97, v97
  v_rcp_f32 v98, v98
  v_rcp_f32 v99, v99
  v_rcp_f32 v100, v100
  v_rcp_f32 v101, v101
  v_pk_mul_f32 v[88:89], v[88:89], v[96:97]
  v_pk_mul_f32 v[90:91], v[90:91], v[98:99]
  v_pk_mul_f32 v[92:93], v[92:93], v[100:101]
  v_cvt_pk_bf16_f32 v104, v88, v89
  v_cvt_pk_bf16_f32 v105, v90, v91
  v_cvt_pk_bf16_f32 v106, v92, v93
  v_dot2_f32_bf16 v22, v104, v120, 0
  v_dot2_f32_bf16 v22, v105, v121, v22
  v_dot2_f32_bf16 v22, v106, v122, v22
  v_pk_mul_f32 v[88:89], v[64:65], s[76:77] op_sel:[0,1] op_sel_hi:[1,1]
  v_pk_mul_f32 v[90:91], v[66:67], s[76:77] op_sel:[0,1] op_sel_hi:[1,1]
  v_pk_mul_f32 v[92:93], v[68:69], s[76:77] op_sel:[0,1] op_sel_hi:[1,1]
  v_cvt_pk_bf16_f32 v104, v88, v89
  v_cvt_pk_bf16_f32 v105, v90, v91
  v_cvt_pk_bf16_f32 v106, v92, v93
  v_lshlrev_b32 v88, 16, v104
  v_and_b32 v89, 0xffff0000, v104
  v_lshlrev_b32 v90, 16, v105
  v_and_b32 v91, 0xffff0000, v105
  v_lshlrev_b32 v92, 16, v106
  v_and_b32 v93, 0xffff0000, v106
  v_pk_add_f32 v[88:89], v[88:89], v[74:75]
  v_pk_add_f32 v[90:91], v[90:91], v[76:77]
  v_pk_add_f32 v[92:93], v[92:93], v[78:79]
  v_cvt_pk_bf16_f32 v104, v88, v89
  v_cvt_pk_bf16_f32 v105, v90, v91
  v_cvt_pk_bf16_f32 v106, v92, v93
  v_lshlrev_b32 v88, 16, v104
  v_and_b32 v89, 0xffff0000, v104
  v_lshlrev_b32 v90, 16, v105
  v_and_b32 v91, 0xffff0000, v105
  v_lshlrev_b32 v92, 16, v106
  v_and_b32 v93, 0xffff0000, v106
  v_pk_mul_f32 v[96:97], v[88:89], v[88:89]
  v_pk_mul_f32 v[98:99], v[90:91], v[90:91]
  v_pk_mul_f32 v[100:101], v[92:93], v[92:93]
  v_pk_fma_f32 v[96:97], v[96:97], s[82:83], v[86:87] op_sel_hi:[1,0,0]
  v_pk_fma_f32 v[98:99], v[98:99], s[82:83], v[86:87] op_sel_hi:[1,0,0]
  v_pk_fma_f32 v[100:101], v[100:101], s[82:83], v[86:87] op_sel_hi:[1,0,0]
  v_pk_mul_f32 v[96:97], v[96:97], v[88:89]
  v_pk_mul_f32 v[98:99], v[98:99], v[90:91]
  v_pk_mul_f32 v[100:101], v[100:101], v[92:93]
  v_exp_f32 v96, v96
  v_exp_f32 v97, v97
  v_exp_f32 v98, v98
  v_exp_f32 v99, v99
  v_exp_f32 v100, v100
  v_exp_f32 v101, v101
  v_pk_add_f32 v[96:97], v[96:97], 1.0 op_sel_hi:[1,0]
  v_pk_add_f32 v[98:99], v[98:99], 1.0 op_sel_hi:[1,0]
  v_pk_add_f32 v[100:101], v[100:101], 1.0 op_sel_hi:[1,0]
  v_rcp_f32 v96, v96
  v_rcp_f32 v97, v97
  v_rcp_f32 v98, v98
  v_rcp_f32 v99, v99
  v_rcp_f32 v100, v100
  v_rcp_f32 v101, v101
  v_pk_mul_f32 v[88:89], v[88:89], v[96:97]
  v_pk_mul_f32 v[90:91], v[90:91], v[98:99]
  v_pk_mul_f32 v[92:93], v[92:93], v[100:101]
  v_cvt_pk_bf16_f32 v104, v88, v89
  v_cvt_pk_bf16_f32 v105, v90, v91
  v_cvt_pk_bf16_f32 v106, v92, v93
  v_dot2_f32_bf16 v23, v104, v120, 0
  v_dot2_f32_bf16 v23, v105, v121, v23
  v_dot2_f32_bf16 v23, v106, v122, v23
  v_pk_mul_f32 v[88:89], v[64:65], s[78:79] op_sel:[0,0] op_sel_hi:[1,0]
  v_pk_mul_f32 v[90:91], v[66:67], s[78:79] op_sel:[0,0] op_sel_hi:[1,0]
  v_pk_mul_f32 v[92:93], v[68:69], s[78:79] op_sel:[0,0] op_sel_hi:[1,0]
  v_cvt_pk_bf16_f32 v104, v88, v89
  v_cvt_pk_bf16_f32 v105, v90, v91
  v_cvt_pk_bf16_f32 v106, v92, v93
  v_lshlrev_b32 v88, 16, v104
  v_and_b32 v89, 0xffff0000, v104
  v_lshlrev_b32 v90, 16, v105
  v_and_b32 v91, 0xffff0000, v105
  v_lshlrev_b32 v92, 16, v106
  v_and_b32 v93, 0xffff0000, v106
  v_pk_add_f32 v[88:89], v[88:89], v[74:75]
  v_pk_add_f32 v[90:91], v[90:91], v[76:77]
  v_pk_add_f32 v[92:93], v[92:93], v[78:79]
  v_cvt_pk_bf16_f32 v104, v88, v89
  v_cvt_pk_bf16_f32 v105, v90, v91
  v_cvt_pk_bf16_f32 v106, v92, v93
  v_lshlrev_b32 v88, 16, v104
  v_and_b32 v89, 0xffff0000, v104
  v_lshlrev_b32 v90, 16, v105
  v_and_b32 v91, 0xffff0000, v105
  v_lshlrev_b32 v92, 16, v106
  v_and_b32 v93, 0xffff0000, v106
  v_pk_mul_f32 v[96:97], v[88:89], v[88:89]
  v_pk_mul_f32 v[98:99], v[90:91], v[90:91]
  v_pk_mul_f32 v[100:101], v[92:93], v[92:93]
  v_pk_fma_f32 v[96:97], v[96:97], s[82:83], v[86:87] op_sel_hi:[1,0,0]
  v_pk_fma_f32 v[98:99], v[98:99], s[82:83], v[86:87] op_sel_hi:[1,0,0]
  v_pk_fma_f32 v[100:101], v[100:101], s[82:83], v[86:87] op_sel_hi:[1,0,0]
  v_pk_mul_f32 v[96:97], v[96:97], v[88:89]
  v_pk_mul_f32 v[98:99], v[98:99], v[90:91]
  v_pk_mul_f32 v[100:101], v[100:101], v[92:93]
  v_exp_f32 v96, v96
  v_exp_f32 v97, v97
  v_exp_f32 v98, v98
  v_exp_f32 v99, v99
  v_exp_f32 v100, v100
  v_exp_f32 v101, v101
  v_pk_add_f32 v[96:97], v[96:97], 1.0 op_sel_hi:[1,0]
  v_pk_add_f32 v[98:99], v[98:99], 1.0 op_sel_hi:[1,0]
  v_pk_add_f32 v[100:101], v[100:101], 1.0 op_sel_hi:[1,0]
  v_rcp_f32 v96, v96
  v_rcp_f32 v97, v97
  v_rcp_f32 v98, v98
  v_rcp_f32 v99, v99
  v_rcp_f32 v100, v100
  v_rcp_f32 v101, v101
  v_pk_mul_f32 v[88:89], v[88:89], v[96:97]
  v_pk_mul_f32 v[90:91], v[90:91], v[98:99]
  v_pk_mul_f32 v[92:93], v[92:93], v[100:101]
  v_cvt_pk_bf16_f32 v104, v88, v89
  v_cvt_pk_bf16_f32 v105, v90, v91
  v_cvt_pk_bf16_f32 v106, v92, v93
  v_dot2_f32_bf16 v24, v104, v120, 0
  v_dot2_f32_bf16 v24, v105, v121, v24
  v_dot2_f32_bf16 v24, v106, v122, v24
  v_pk_mul_f32 v[88:89], v[64:65], s[78:79] op_sel:[0,1] op_sel_hi:[1,1]
  v_pk_mul_f32 v[90:91], v[66:67], s[78:79] op_sel:[0,1] op_sel_hi:[1,1]
  v_pk_mul_f32 v[92:93], v[68:69], s[78:79] op_sel:[0,1] op_sel_hi:[1,1]
  v_cvt_pk_bf16_f32 v104, v88, v89
  v_cvt_pk_bf16_f32 v105, v90, v91
  v_cvt_pk_bf16_f32 v106, v92, v93
  v_lshlrev_b32 v88, 16, v104
  v_and_b32 v89, 0xffff0000, v104
  v_lshlrev_b32 v90, 16, v105
  v_and_b32 v91, 0xffff0000, v105
  v_lshlrev_b32 v92, 16, v106
  v_and_b32 v93, 0xffff0000, v106
  v_pk_add_f32 v[88:89], v[88:89], v[74:75]
  v_pk_add_f32 v[90:91], v[90:91], v[76:77]
  v_pk_add_f32 v[92:93], v[92:93], v[78:79]
  v_cvt_pk_bf16_f32 v104, v88, v89
  v_cvt_pk_bf16_f32 v105, v90, v91
  v_cvt_pk_bf16_f32 v106, v92, v93
  v_lshlrev_b32 v88, 16, v104
  v_and_b32 v89, 0xffff0000, v104
  v_lshlrev_b32 v90, 16, v105
  v_and_b32 v91, 0xffff0000, v105
  v_lshlrev_b32 v92, 16, v106
  v_and_b32 v93, 0xffff0000, v106
  v_pk_mul_f32 v[96:97], v[88:89], v[88:89]
  v_pk_mul_f32 v[98:99], v[90:91], v[90:91]
  v_pk_mul_f32 v[100:101], v[92:93], v[92:93]
  v_pk_fma_f32 v[96:97], v[96:97], s[82:83], v[86:87] op_sel_hi:[1,0,0]
  v_pk_fma_f32 v[98:99], v[98:99], s[82:83], v[86:87] op_sel_hi:[1,0,0]
  v_pk_fma_f32 v[100:101], v[100:101], s[82:83], v[86:87] op_sel_hi:[1,0,0]
  v_pk_mul_f32 v[96:97], v[96:97], v[88:89]
  v_pk_mul_f32 v[98:99], v[98:99], v[90:91]
  v_pk_mul_f32 v[100:101], v[100:101], v[92:93]
  v_exp_f32 v96, v96
  v_exp_f32 v97, v97
  v_exp_f32 v98, v98
  v_exp_f32 v99, v99
  v_exp_f32 v100, v100
  v_exp_f32 v101, v101
  v_pk_add_f32 v[96:97], v[96:97], 1.0 op_sel_hi:[1,0]
  v_pk_add_f32 v[98:99], v[98:99], 1.0 op_sel_hi:[1,0]
  v_pk_add_f32 v[100:101], v[100:101], 1.0 op_sel_hi:[1,0]
  v_rcp_f32 v96, v96
  v_rcp_f32 v97, v97
  v_rcp_f32 v98, v98
  v_rcp_f32 v99, v99
  v_rcp_f32 v100, v100
  v_rcp_f32 v101, v101
  v_pk_mul_f32 v[88:89], v[88:89], v[96:97]
  v_pk_mul_f32 v[90:91], v[90:91], v[98:99]
  v_pk_mul_f32 v[92:93], v[92:93], v[100:101]
  v_cvt_pk_bf16_f32 v104, v88, v89
  v_cvt_pk_bf16_f32 v105, v90, v91
  v_cvt_pk_bf16_f32 v106, v92, v93
  v_dot2_f32_bf16 v25, v104, v120, 0
  v_dot2_f32_bf16 v25, v105, v121, v25
  v_dot2_f32_bf16 v25, v106, v122, v25
  v_pk_mul_f32 v[88:89], v[64:65], s[80:81] op_sel:[0,0] op_sel_hi:[1,0]
  v_pk_mul_f32 v[90:91], v[66:67], s[80:81] op_sel:[0,0] op_sel_hi:[1,0]
  v_pk_mul_f32 v[92:93], v[68:69], s[80:81] op_sel:[0,0] op_sel_hi:[1,0]
  v_cvt_pk_bf16_f32 v104, v88, v89
  v_cvt_pk_bf16_f32 v105, v90, v91
  v_cvt_pk_bf16_f32 v106, v92, v93
  v_lshlrev_b32 v88, 16, v104
  v_and_b32 v89, 0xffff0000, v104
  v_lshlrev_b32 v90, 16, v105
  v_and_b32 v91, 0xffff0000, v105
  v_lshlrev_b32 v92, 16, v106
  v_and_b32 v93, 0xffff0000, v106
  v_pk_add_f32 v[88:89], v[88:89], v[74:75]
  v_pk_add_f32 v[90:91], v[90:91], v[76:77]
  v_pk_add_f32 v[92:93], v[92:93], v[78:79]
  v_cvt_pk_bf16_f32 v104, v88, v89
  v_cvt_pk_bf16_f32 v105, v90, v91
  v_cvt_pk_bf16_f32 v106, v92, v93
  v_lshlrev_b32 v88, 16, v104
  v_and_b32 v89, 0xffff0000, v104
  v_lshlrev_b32 v90, 16, v105
  v_and_b32 v91, 0xffff0000, v105
  v_lshlrev_b32 v92, 16, v106
  v_and_b32 v93, 0xffff0000, v106
  v_pk_mul_f32 v[96:97], v[88:89], v[88:89]
  v_pk_mul_f32 v[98:99], v[90:91], v[90:91]
  v_pk_mul_f32 v[100:101], v[92:93], v[92:93]
  v_pk_fma_f32 v[96:97], v[96:97], s[82:83], v[86:87] op_sel_hi:[1,0,0]
  v_pk_fma_f32 v[98:99], v[98:99], s[82:83], v[86:87] op_sel_hi:[1,0,0]
  v_pk_fma_f32 v[100:101], v[100:101], s[82:83], v[86:87] op_sel_hi:[1,0,0]
  v_pk_mul_f32 v[96:97], v[96:97], v[88:89]
  v_pk_mul_f32 v[98:99], v[98:99], v[90:91]
  v_pk_mul_f32 v[100:101], v[100:101], v[92:93]
  v_exp_f32 v96, v96
  v_exp_f32 v97, v97
  v_exp_f32 v98, v98
  v_exp_f32 v99, v99
  v_exp_f32 v100, v100
  v_exp_f32 v101, v101
  v_pk_add_f32 v[96:97], v[96:97], 1.0 op_sel_hi:[1,0]
  v_pk_add_f32 v[98:99], v[98:99], 1.0 op_sel_hi:[1,0]
  v_pk_add_f32 v[100:101], v[100:101], 1.0 op_sel_hi:[1,0]
  v_rcp_f32 v96, v96
  v_rcp_f32 v97, v97
  v_rcp_f32 v98, v98
  v_rcp_f32 v99, v99
  v_rcp_f32 v100, v100
  v_rcp_f32 v101, v101
  v_pk_mul_f32 v[88:89], v[88:89], v[96:97]
  v_pk_mul_f32 v[90:91], v[90:91], v[98:99]
  v_pk_mul_f32 v[92:93], v[92:93], v[100:101]
  v_cvt_pk_bf16_f32 v104, v88, v89
  v_cvt_pk_bf16_f32 v105, v90, v91
  v_cvt_pk_bf16_f32 v106, v92, v93
  v_dot2_f32_bf16 v26, v104, v120, 0
  v_dot2_f32_bf16 v26, v105, v121, v26
  v_dot2_f32_bf16 v26, v106, v122, v26
  v_pk_mul_f32 v[88:89], v[64:65], s[80:81] op_sel:[0,1] op_sel_hi:[1,1]
  v_pk_mul_f32 v[90:91], v[66:67], s[80:81] op_sel:[0,1] op_sel_hi:[1,1]
  v_pk_mul_f32 v[92:93], v[68:69], s[80:81] op_sel:[0,1] op_sel_hi:[1,1]
  v_cvt_pk_bf16_f32 v104, v88, v89
  v_cvt_pk_bf16_f32 v105, v90, v91
  v_cvt_pk_bf16_f32 v106, v92, v93
  v_lshlrev_b32 v88, 16, v104
  v_and_b32 v89, 0xffff0000, v104
  v_lshlrev_b32 v90, 16, v105
  v_and_b32 v91, 0xffff0000, v105
  v_lshlrev_b32 v92, 16, v106
  v_and_b32 v93, 0xffff0000, v106
  v_pk_add_f32 v[88:89], v[88:89], v[74:75]
  v_pk_add_f32 v[90:91], v[90:91], v[76:77]
  v_pk_add_f32 v[92:93], v[92:93], v[78:79]
  v_cvt_pk_bf16_f32 v104, v88, v89
  v_cvt_pk_bf16_f32 v105, v90, v91
  v_cvt_pk_bf16_f32 v106, v92, v93
  v_lshlrev_b32 v88, 16, v104
  v_and_b32 v89, 0xffff0000, v104
  v_lshlrev_b32 v90, 16, v105
  v_and_b32 v91, 0xffff0000, v105
  v_lshlrev_b32 v92, 16, v106
  v_and_b32 v93, 0xffff0000, v106
  v_pk_mul_f32 v[96:97], v[88:89], v[88:89]
  v_pk_mul_f32 v[98:99], v[90:91], v[90:91]
  v_pk_mul_f32 v[100:101], v[92:93], v[92:93]
  v_pk_fma_f32 v[96:97], v[96:97], s[82:83], v[86:87] op_sel_hi:[1,0,0]
  v_pk_fma_f32 v[98:99], v[98:99], s[82:83], v[86:87] op_sel_hi:[1,0,0]
  v_pk_fma_f32 v[100:101], v[100:101], s[82:83], v[86:87] op_sel_hi:[1,0,0]
  v_pk_mul_f32 v[96:97], v[96:97], v[88:89]
  v_pk_mul_f32 v[98:99], v[98:99], v[90:91]
  v_pk_mul_f32 v[100:101], v[100:101], v[92:93]
  v_exp_f32 v96, v96
  v_exp_f32 v97, v97
  v_exp_f32 v98, v98
  v_exp_f32 v99, v99
  v_exp_f32 v100, v100
  v_exp_f32 v101, v101
  v_pk_add_f32 v[96:97], v[96:97], 1.0 op_sel_hi:[1,0]
  v_pk_add_f32 v[98:99], v[98:99], 1.0 op_sel_hi:[1,0]
  v_pk_add_f32 v[100:101], v[100:101], 1.0 op_sel_hi:[1,0]
  v_rcp_f32 v96, v96
  v_rcp_f32 v97, v97
  v_rcp_f32 v98, v98
  v_rcp_f32 v99, v99
  v_rcp_f32 v100, v100
  v_rcp_f32 v101, v101
  v_pk_mul_f32 v[88:89], v[88:89], v[96:97]
  v_pk_mul_f32 v[90:91], v[90:91], v[98:99]
  v_pk_mul_f32 v[92:93], v[92:93], v[100:101]
  v_cvt_pk_bf16_f32 v104, v88, v89
  v_cvt_pk_bf16_f32 v105, v90, v91
  v_cvt_pk_bf16_f32 v106, v92, v93
  v_dot2_f32_bf16 v27, v104, v120, 0
  v_dot2_f32_bf16 v27, v105, v121, v27
  v_dot2_f32_bf16 v27, v106, v122, v27
  s_nop 2
  v_permlane32_swap_b32 v20, v21
  v_permlane32_swap_b32 v22, v23
  v_permlane32_swap_b32 v24, v25
  v_permlane32_swap_b32 v26, v27
  v_add_f32 v20, v20, v21
  v_add_f32 v22, v22, v23
  v_add_f32 v24, v24, v25
  v_add_f32 v26, v26, v27
  v_permlane16_swap_b32 v20, v22
  s_nop 0
  v_permlane16_swap_b32 v24, v26
  v_add_f32 v20, v20, v22
  v_add_f32 v24, v24, v26
  s_nop 0
  v_add_f32_dpp v20, v20, v20 row_ror:8 row_mask:0xf bank_mask:0xf
  s_nop 1
  v_add_f32_dpp v20, v24, v24 row_ror:8 row_mask:0xf bank_mask:0xc
  s_nop 1
  v_add_f32_dpp v20, v20, v20 row_half_mirror row_mask:0xf bank_mask:0xf
  s_nop 1
  v_add_f32_dpp v20, v20, v20 quad_perm:[1,0,3,2] row_mask:0xf bank_mask:0xf
  s_nop 1
  v_add_f32_dpp v20, v20, v20 quad_perm:[2,3,0,1] row_mask:0xf bank_mask:0xf
  ds_write_b32 v9, v20
  v_add_u32 v9, 128, v9
  s_add_u32 s51, s51, 1
  s_cmp_lt_u32 s51, 2
  s_cbranch_scc1 L_mlp
L_nomlp:
  s_waitcnt lgkmcnt(0)
  s_barrier
  ds_read_b64_tr_b16 v[128:129], v40 offset:0
  ds_read_b64_tr_b16 v[130:131], v40 offset:1024
  ds_read_b64_tr_b16 v[132:133], v40 offset:8192
  ds_read_b64_tr_b16 v[134:135], v40 offset:9216
  ds_read_b64_tr_b16 v[144:145], v41 offset:0
  ds_read_b64_tr_b16 v[146:147], v41 offset:1024
  ds_read_b64_tr_b16 v[148:149], v41 offset:8192
  ds_read_b64_tr_b16 v[150:151], v41 offset:9216
  ds_read_b64_tr_b16 v[160:161], v42 offset:0
  ds_read_b64_tr_b16 v[162:163], v42 offset:1024
  ds_read_b64_tr_b16 v[164:165], v42 offset:8192
  ds_read_b64_tr_b16 v[166:167], v42 offset:9216
  ds_read_b64_tr_b16 v[176:177], v43 offset:0
  ds_read_b64_tr_b16 v[178:179], v43 offset:1024
  ds_read_b64_tr_b16 v[180:181], v43 offset:8192
  ds_read_b64_tr_b16 v[182:183], v43 offset:9216
  ds_read_b64_tr_b16 v[192:193], v44 offset:0
  ds_read_b64_tr_b16 v[194:195], v44 offset:1024
  ds_read_b64_tr_b16 v[196:197], v44 offset:8192
  ds_read_b64_tr_b16 v[198:199], v44 offset:9216
  ds_read_b64_tr_b16 v[208:209], v45 offset:0
  ds_read_b64_tr_b16 v[210:211], v45 offset:1024
  ds_read_b64_tr_b16 v[212:213], v45 offset:8192
  ds_read_b64_tr_b16 v[214:215], v45 offset:9216
  ds_read_b64_tr_b16 v[224:225], v46 offset:0
  ds_read_b64_tr_b16 v[226:227], v46 offset:1024
  ds_read_b64_tr_b16 v[228:229], v46 offset:8192
  ds_read_b64_tr_b16 v[230:231], v46 offset:9216
  ds_read_b64_tr_b16 v[240:241], v47 offset:0
  ds_read_b64_tr_b16 v[242:243], v47 offset:1024
  ds_read_b64_tr_b16 v[244:245], v47 offset:8192
  ds_read_b64_tr_b16 v[246:247], v47 offset:9216
  s_cmp_lg_u32 s31, 0
  s_cbranch_scc1 L_G1_nolam
  v_mov_b32 v14, 154128
  ds_read_b128 v[20:23], v14
  ds_read_b128 v[24:27], v14 offset:16
  s_waitcnt lgkmcnt(0)
  v_max3_f32 v30, v20, v22, v24
  v_max_f32 v30, v30, v26
  v_sub_f32 v20, v20, v30
  v_sub_f32 v22, v22, v30
  v_sub_f32 v24, v24, v30
  v_sub_f32 v26, v26, v30
  v_exp_f32 v20, v20
  v_exp_f32 v22, v22
  v_exp_f32 v24, v24
  v_exp_f32 v26, v26
  v_mul_f32 v29, v20, v21
  v_fmac_f32 v29, v22, v23
  v_fmac_f32 v29, v24, v25
  v_fmac_f32 v29, v26, v27
  v_log_f32 v29, v29
  s_nop 0
  v_add_f32 v36, v30, v29
  s_mov_b64 exec, 1
  global_store_dwordx2 v15, v[36:37], s[28:29] sc1
  s_mov_b64 exec, -1
L_G1_nolam:
  s_barrier
  ds_read_b64_tr_b16 v[136:137], v40 offset:16384
  ds_read_b64_tr_b16 v[138:139], v40 offset:17408
  ds_read_b64_tr_b16 v[140:141], v40 offset:24576
  ds_read_b64_tr_b16 v[142:143], v40 offset:25600
  ds_read_b64_tr_b16 v[152:153], v41 offset:16384
  ds_read_b64_tr_b16 v[154:155], v41 offset:17408
  ds_read_b64_tr_b16 v[156:157], v41 offset:24576
  ds_read_b64_tr_b16 v[158:159], v41 offset:25600
  ds_read_b64_tr_b16 v[168:169], v42 offset:16384
  ds_read_b64_tr_b16 v[170:171], v42 offset:17408
  ds_read_b64_tr_b16 v[172:173], v42 offset:24576
  ds_read_b64_tr_b16 v[174:175], v42 offset:25600
  ds_read_b64_tr_b16 v[184:185], v43 offset:16384
  ds_read_b64_tr_b16 v[186:187], v43 offset:17408
  ds_read_b64_tr_b16 v[188:189], v43 offset:24576
  ds_read_b64_tr_b16 v[190:191], v43 offset:25600
  ds_read_b64_tr_b16 v[200:201], v44 offset:16384
  ds_read_b64_tr_b16 v[202:203], v44 offset:17408
  ds_read_b64_tr_b16 v[204:205], v44 offset:24576
  ds_read_b64_tr_b16 v[206:207], v44 offset:25600
  ds_read_b64_tr_b16 v[216:217], v45 offset:16384
  ds_read_b64_tr_b16 v[218:219], v45 offset:17408
  ds_read_b64_tr_b16 v[220:221], v45 offset:24576
  ds_read_b64_tr_b16 v[222:223], v45 offset:25600
  ds_read_b64_tr_b16 v[232:233], v46 offset:16384
  ds_read_b64_tr_b16 v[234:235], v46 offset:17408
  ds_read_b64_tr_b16 v[236:237], v46 offset:24576
  ds_read_b64_tr_b16 v[238:239], v46 offset:25600
  ds_read_b64_tr_b16 v[248:249], v47 offset:16384
  ds_read_b64_tr_b16 v[250:251], v47 offset:17408
  ds_read_b64_tr_b16 v[252:253], v47 offset:24576
  ds_read_b64_tr_b16 v[254:255], v47 offset:25600
  v_mov_b64 v[96:97], 0
  v_mov_b64 v[98:99], 0
  v_mov_b64 v[100:101], 0
  v_mov_b64 v[102:103], 0
  v_mov_b64 v[104:105], 0
  v_mov_b64 v[106:107], 0
  v_mov_b64 v[108:109], 0
  v_mov_b64 v[110:111], 0
  s_mov_b32 s56, 0xffff
  s_mov_b32 s57, s56
  s_waitcnt lgkmcnt(0)
  s_barrier
  ds_read_b128 v[64:67], v48 offset:0
  ds_read_b128 v[68:71], v49 offset:0
  ds_read_b128 v[72:75], v48 offset:64
  ds_read_b128 v[76:79], v49 offset:64
  s_waitcnt lgkmcnt(3)
  v_smfmac_f32_16x16x64_bf16 v[96:99], v[64:67], v[128:135], v39
  s_waitcnt lgkmcnt(2)
  v_smfmac_f32_16x16x64_bf16 v[96:99], v[68:71], v[192:199], v39
  s_waitcnt lgkmcnt(1)
  v_smfmac_f32_16x16x64_bf16 v[96:99], v[72:75], v[136:143], v39
  s_waitcnt lgkmcnt(0)
  v_smfmac_f32_16x16x64_bf16 v[96:99], v[76:79], v[200:207], v39
  v_smfmac_f32_16x16x64_bf16 v[100:103], v[64:67], v[144:151], v39
  v_smfmac_f32_16x16x64_bf16 v[100:103], v[68:71], v[208:215], v39
  v_smfmac_f32_16x16x64_bf16 v[100:103], v[72:75], v[152:159], v39
  v_smfmac_f32_16x16x64_bf16 v[100:103], v[76:79], v[216:223], v39
  v_smfmac_f32_16x16x64_bf16 v[104:107], v[64:67], v[160:167], v39
  v_smfmac_f32_16x16x64_bf16 v[104:107], v[68:71], v[224:231], v39
  v_smfmac_f32_16x16x64_bf16 v[104:107], v[72:75], v[168:175], v39
  v_smfmac_f32_16x16x64_bf16 v[104:107], v[76:79], v[232:239], v39
  v_add_f32 v96, v96, v97
  v_add_f32 v98, v98, v99
  v_add_f32 v96, v96, v98
  v_mov_b32 v97, v96
  s_nop 1
  v_permlane16_swap_b32 v96, v97
  v_add_f32 v96, v96, v97
  v_and_or_b32 v52, v96, v51, s65
  v_smfmac_f32_16x16x64_bf16 v[108:111], v[64:67], v[176:183], v39
  v_smfmac_f32_16x16x64_bf16 v[108:111], v[68:71], v[240:247], v39
  v_smfmac_f32_16x16x64_bf16 v[108:111], v[72:75], v[184:191], v39
  v_smfmac_f32_16x16x64_bf16 v[108:111], v[76:79], v[248:255], v39
  v_add_f32 v100, v100, v101
  v_add_f32 v102, v102, v103
  v_add_f32 v100, v100, v102
  v_mov_b32 v101, v100
  s_nop 1
  v_permlane16_swap_b32 v100, v101
  v_add_f32 v100, v100, v101
  v_and_or_b32 v53, v100, v51, s66
  v_add_f32 v104, v104, v105
  v_add_f32 v106, v106, v107
  v_add_f32 v104, v104, v106
  v_mov_b32 v105, v104
  s_nop 1
  v_permlane16_swap_b32 v104, v105
  v_add_f32 v104, v104, v105
  v_and_or_b32 v54, v104, v51, s67
  v_add_f32 v108, v108, v109
  v_add_f32 v110, v110, v111
  v_add_f32 v108, v108, v110
  v_mov_b32 v109, v108
  s_nop 1
  v_permlane16_swap_b32 v108, v109
  v_add_f32 v108, v108, v109
  v_and_or_b32 v55, v108, v51, s68
  s_mov_b64 exec, s[56:57]
  global_store_dwordx4 v50, v[52:55], s[28:29] sc1
  s_waitcnt vmcnt(0)
  s_barrier
  s_endpgm
.section .rodata,"a"
.p2align 6
.amdhsa_kernel parallel_sum__sliding_block_cached__mixer_token_mlp__decode_kernel
  .amdhsa_next_free_vgpr 256
  .amdhsa_next_free_sgpr 102
  .amdhsa_accum_offset 256
  .amdhsa_group_segment_fixed_size 0
  .amdhsa_kernarg_size 104
  .amdhsa_user_sgpr_count 2
  .amdhsa_user_sgpr_kernarg_segment_ptr 1
  .amdhsa_system_sgpr_workgroup_id_x 1
.end_amdhsa_kernel
```
